```python
import torch

def _softmax(x, axis=-1):
    return torch.softmax(x, dim=axis)
def _gelu(x):
    return torch.nn.functional.gelu(x, approximate="tanh")
def _silu(x):
    return torch.nn.functional.silu(x)
def _sigmoid(x):
    return torch.sigmoid(x)
def _layernorm(x, axis=-1, eps=1e-5):
    m = x.mean(dim=axis, keepdim=True)
    v = x.var(dim=axis, keepdim=True, unbiased=False)
    return (x - m) / torch.sqrt(v + eps)
def _scatter_add(tgt, idx, src, axis=0):
    return tgt.clone().index_add_(axis, idx, src)
def _segment_sum(src, seg, n):
    out = torch.zeros((n,) + src.shape[1:], dtype=src.dtype)
    return out.index_add_(0, seg, src)
def _pad(x, pw):
    flat = tuple(v for pair in reversed(pw) for v in pair)
    return torch.nn.functional.pad(x, flat)

kernel_name = 'standalone__grouped__vision'

def setup_inputs():

    _w = (lambda a: (lambda t: t.to(torch.bfloat16) if t.is_floating_point() else t)(torch.as_tensor(a)))
    H = W = 224
    G = 4
    Cg = max(96 // G, 2)
    C = G * Cg
    k = 5
    scale = 1.0 / (k * Cg ** 0.5)
    return {
        "x": _w((lambda *s: torch.randn(*s, dtype=torch.bfloat16) * 0.05)(1, H, W, C)),
        "w": _w((lambda *s: torch.randn(*s, dtype=torch.bfloat16) * 0.05)(k, k, G, Cg, Cg) * scale),
    }

def reference(x, w):
    B, H, W, C = x.shape
    k = w.shape[0]
    G = w.shape[2]
    Cg = C // G
    pad = k // 2
    xp = _pad(x, ((0,0),(pad,pad),(pad,pad),(0,0)))
    xg = xp.reshape(B, H + 2 * pad, W + 2 * pad, G, Cg)
    out = torch.zeros_like(x).reshape(B, H, W, G, Cg)
    for i in range(k):
        for j in range(k):
            out = out + torch.einsum('bhwgc,gcd->bhwgd', xg[:, i:i+H, j:j+W, :, :], w[i, j])
    return out.reshape(B, H, W, C)
```

```asm
; @launch grid=(256,1,1) block=(512,1,1) lds=163616
.amdgcn_target "amdgcn-amd-amdhsa--gfx950"
.text
.p2align 12
.globl standalone__grouped__vision_kernel
.p2align 8
.type standalone__grouped__vision_kernel,@function
standalone__grouped__vision_kernel:
    s_load_dwordx4 s[4:7], s[0:1], 0
    s_load_dwordx2 s[8:9], s[0:1], 16
    v_lshrrev_b32 v2, 6, v0
    v_and_b32 v1, 63, v0
    v_readfirstlane_b32 s27, v2
    s_and_b32 s3, s2, 7
    s_lshr_b32 s32, s2, 3
    s_lshl_b32 s3, s3, 5
    s_add_u32 s29, s32, s3
    s_cmpk_ge_u32 s29, 252
    s_cbranch_scc1 L_end
    s_cmp_ge_u32 s32, 32
    s_cbranch_scc1 L_end
    s_cmp_ge_u32 s27, 4
    s_cbranch_scc1 L_rolecomp
    s_cmp_lg_u32 s27, 0
    s_cbranch_scc1 L_hop
L_roleload:
    s_setprio 3
    s_getpc_b64 s[22:23]
L_pc:
    s_bfe_u32 s30, s32, 0x30001
    s_lshl_b32 s30, s30, 11
    v_lshl_add_u32 v3, v1, 7, s30
    v_min_u32 v3, L_progend-L_pc, v3
    s_bitcmp1_b32 s32, 0
    s_cselect_b32 exec_lo, 0xffff, 1
    s_mov_b32 exec_hi, 0
    global_load_dword v4, v3, s[22:23]
    s_mov_b64 exec, -1
    s_and_b32 s24, s29, 1
    s_cmpk_lt_u32 s29, 224
    s_cselect_b32 s34, s24, 0
    s_mul_i32 s26, s29, 2341
    s_lshr_b32 s26, s26, 16
    s_mul_i32 s3, s26, 28
    s_sub_u32 s25, s29, s3
    s_lshr_b32 s25, s25, 1
    s_mul_i32 s33, s26, 25
    s_cmp_lg_u32 s24, 0
    s_cselect_b32 s3, 12, 15
    s_cselect_b32 s28, 1, -1
    s_add_u32 s33, s33, s3
    s_mul_i32 s33, s33, 14
    s_add_u32 s33, s33, s25
    s_mulk_i32 s33, 3072
    s_mul_i32 s28, s28, 43008
    s_cmp_eq_u32 s25, 0
    s_cselect_b32 s30, 24, 0
    s_cmp_eq_u32 s25, 13
    s_cselect_b32 s31, 24, 48
    v_mov_b32 v54, 163328
    v_lshl_add_u32 v54, v1, 2, v54
    ds_write_b32 v54, v54
    v_bfrev_b32 v52, 1
    v_cmp_gt_u32 vcc, s30, v1
    v_add_u32 v2, 16, v1
    v_lshrrev_b32 v2, 6, v2
    v_xor_b32 v2, v2, v1
    v_lshlrev_b32 v8, 4, v2
    v_cndmask_b32 v8, v8, v52, vcc
    v_cmp_le_u32 vcc, s31, v1
    v_lshrrev_b32 v2, 5, v1
    v_add_u32 v2, 1, v2
    v_xor_b32 v2, v2, v1
    v_lshlrev_b32 v9, 4, v2
    v_add_u32 v2, 0xb0, v1
    v_lshrrev_b32 v2, 6, v2
    v_xor_b32 v2, v2, v1
    v_lshlrev_b32 v10, 4, v2
    v_lshlrev_b32 v11, 4, v1
    v_cndmask_b32 v11, v11, v52, vcc
    s_mov_b32 s15, 0x20000
    s_mov_b32 s19, 0x20000
    s_mov_b32 s18, 115712
    s_mov_b32 s14, 9720192
    s_lshr_b32 s30, s32, 1
    s_cmp_lg_u32 s24, 0
    s_cselect_b32 s3, 13, 52
    s_cselect_b32 s31, 0, 23040
    s_mul_i32 s30, s30, s3
    s_lshl_b32 s30, s30, 7
    s_add_u32 s30, s30, s31
    s_addk_i32 s30, 512
    v_lshl_add_u32 v6, v1, 7, s30
    v_lshrrev_b32 v2, 5, v1
    v_mul_u32_u24 v2, 38912, v2
    v_lshl_add_u32 v2, v1, 7, v2
    v_add_u32 v7, 43008, v2
    s_mov_b32 m0, 0
    s_cmp_lg_u32 s24, 0
    s_cselect_b32 exec_lo, 8191, 1
    s_mov_b32 exec_hi, 0
    s_waitcnt lgkmcnt(0)
    s_sub_u32 s16, s6, 512
    s_subb_u32 s17, s7, 0
    s_and_b32 s17, s17, 0xffff
    buffer_load_dword v4, v6, s[16:19], 0 offen
    s_mov_b64 exec, -1
    s_sub_u32 s12, s4, 86400
    s_subb_u32 s13, s5, 0
    s_and_b32 s13, s13, 0xffff
    s_mov_b32 exec_lo, 0x3fffffff
    s_mov_b32 exec_hi, exec_lo
    s_cmp_eq_u32 s34, 1
    s_cbranch_scc1 L_hpf
    buffer_load_dword v5, v7, s[12:15], s33 offen nt
    s_mov_b64 exec, -1
L_xa:
    buffer_load_dwordx4 v8, s[12:15], s33 offen offset:0 nt lds
    buffer_load_dwordx4 v9, s[12:15], s33 offen offset:1024 nt lds
    buffer_load_dwordx4 v10, s[12:15], s33 offen offset:2048 nt lds
    buffer_load_dwordx4 v11, s[12:15], s33 offen offset:3072 nt lds
    s_addk_i32 m0, 3840
    s_add_u32 s33, s33, s28
    buffer_load_dwordx4 v8, s[12:15], s33 offen offset:0 nt lds
    buffer_load_dwordx4 v9, s[12:15], s33 offen offset:1024 nt lds
    buffer_load_dwordx4 v10, s[12:15], s33 offen offset:2048 nt lds
    buffer_load_dwordx4 v11, s[12:15], s33 offen offset:3072 nt lds
    s_addk_i32 m0, 3840
    s_add_u32 s33, s33, s28
    s_cmpk_lt_u32 m0, 23040
    s_cbranch_scc1 L_xa
    s_branch L_pat0
L_hop:
    s_cmp_eq_u32 s27, 3
    s_cbranch_scc1 L_padret
    s_and_b32 s24, s29, 1
    s_cmpk_lt_u32 s29, 224
    s_cselect_b32 s34, s24, 0
    s_mov_b64 exec, 0
    s_lshl_b32 s3, s34, 1
    s_add_u32 s3, s3, s27
    s_cmp_eq_u32 s3, 1
    s_cbranch_scc1 L_go12
    s_cmp_eq_u32 s3, 2
    s_cbranch_scc1 L_padc
    s_cmp_eq_u32 s3, 3
    s_cbranch_scc1 L_go13
    s_branch L_padb
L_hpf:
    s_mov_b64 exec, -1
    s_branch L_pat
L_pat0:
    s_mov_b32 exec_hi, 1048575
    buffer_load_dword v4, v6, s[16:19], 0 offen
    s_mov_b32 exec_hi, -1
L_pat:
    s_movk_i32 s30, -24
    s_movk_i32 s31, -46
    s_movk_i32 s3, 171
    v_add_u32 v43, 32, v1
    v_mov_b32 v40, v1
    v_mul_u32_u24 v42, s3, v40
    v_lshrrev_b32 v42, 12, v42
    v_mad_i32_i24 v41, v42, s30, v40
    v_lshrrev_b32 v42, 1, v41
    v_add_u32 v42, v42, v41
    v_mad_i32_i24 v51, v41, 3, s31
    v_min_u32 v42, v42, v51
    v_sub_u32 v41, v43, v41
    v_add_lshl_u32 v44, v41, v42, 4
    v_add_u32 v51, 12, v42
    v_add_u32 v42, -12, v42
    v_min_u32 v42, v42, v51
    v_add_lshl_u32 v47, v41, v42, 4
    v_add_u32 v40, 64, v40
    v_mul_u32_u24 v42, s3, v40
    v_lshrrev_b32 v42, 12, v42
    v_mad_i32_i24 v41, v42, s30, v40
    v_lshrrev_b32 v42, 1, v41
    v_add_u32 v42, v42, v41
    v_mad_i32_i24 v51, v41, 3, s31
    v_min_u32 v42, v42, v51
    v_sub_u32 v41, v43, v41
    v_add_lshl_u32 v45, v41, v42, 4
    v_add_u32 v51, 12, v42
    v_add_u32 v42, -12, v42
    v_min_u32 v42, v42, v51
    v_add_lshl_u32 v48, v41, v42, 4
    v_cmp_gt_u32 vcc, 32, v1
    v_add_u32 v40, 64, v40
    v_mul_u32_u24 v42, s3, v40
    v_lshrrev_b32 v42, 12, v42
    v_mad_i32_i24 v41, v42, s30, v40
    v_lshrrev_b32 v42, 1, v41
    v_add_u32 v42, v42, v41
    v_mad_i32_i24 v51, v41, 3, s31
    v_min_u32 v42, v42, v51
    v_sub_u32 v41, v43, v41
    v_add_lshl_u32 v46, v41, v42, 4
    v_add_u32 v51, 12, v42
    v_add_u32 v42, -12, v42
    v_min_u32 v42, v42, v51
    v_add_lshl_u32 v49, v41, v42, 4
    v_cndmask_b32 v50, v48, v45, vcc
    v_cndmask_b32 v53, v52, v45, vcc
    s_mov_b32 m0, 47104
    s_cmp_lg_u32 s24, 0
    s_cselect_b32 s23, 0, 92160
    s_cselect_b32 s21, 46080, 0
    s_sub_u32 s21, s21, 43520
    s_mov_b32 s38, 163360
    s_cmp_lg_u32 s34, 1
    s_cselect_b32 s36, 0, 163356
    s_cselect_b32 s20, 4, 4
    s_sub_u32 s20, s38, s20
L_wl:
    buffer_load_dwordx4 v44, s[16:19], s23 offen offset:0  lds
    buffer_load_dwordx4 v45, s[16:19], s23 offen offset:1024  lds
    buffer_load_dwordx4 v46, s[16:19], s23 offen offset:2048  lds
    buffer_load_dwordx4 v44, s[16:19], s23 offen offset:3072  lds
    s_addk_i32 m0, 4096
    s_addk_i32 s23, 4096
    buffer_load_dwordx4 v50, s[16:19], s23 offen offset:0  lds
    buffer_load_dwordx4 v49, s[16:19], s23 offen offset:1024  lds
    buffer_load_dwordx4 v47, s[16:19], s23 offen offset:2048  lds
    buffer_load_dwordx4 v48, s[16:19], s23 offen offset:3072  lds
    s_addk_i32 m0, 4096
    s_addk_i32 s23, 4096
    buffer_load_dwordx4 v49, s[16:19], s23 offen offset:0  lds
    buffer_load_dwordx4 v44, s[16:19], s23 offen offset:1024  lds
    buffer_load_dwordx4 v45, s[16:19], s23 offen offset:2048  lds
    buffer_load_dwordx4 v46, s[16:19], s23 offen offset:3072  lds
    s_addk_i32 m0, 4096
    s_addk_i32 s23, 4096
    s_sub_u32 s3, s20, s38
    s_cmp_gt_u32 s3, 4
    s_cbranch_scc1 L_wn
    s_waitcnt vmcnt(36)
    s_barrier
L_wn:
    buffer_load_dwordx4 v44, s[16:19], s23 offen offset:0  lds
    buffer_load_dwordx4 v50, s[16:19], s23 offen offset:1024  lds
    buffer_load_dwordx4 v49, s[16:19], s23 offen offset:2048  lds
    buffer_load_dwordx4 v47, s[16:19], s23 offen offset:3072  lds
    s_addk_i32 m0, 4096
    s_addk_i32 s23, 4096
    buffer_load_dwordx4 v48, s[16:19], s23 offen offset:0  lds
    buffer_load_dwordx4 v49, s[16:19], s23 offen offset:1024  lds
    buffer_load_dwordx4 v44, s[16:19], s23 offen offset:2048  lds
    buffer_load_dwordx4 v45, s[16:19], s23 offen offset:3072  lds
    s_addk_i32 m0, 4096
    s_addk_i32 s23, 4096
    buffer_load_dwordx4 v46, s[16:19], s23 offen offset:0  lds
    buffer_load_dwordx4 v44, s[16:19], s23 offen offset:1024  lds
    buffer_load_dwordx4 v53, s[16:19], s23 offen offset:2048  lds
    s_add_u32 s3, m0, 2688
    s_mov_b32 m0, s38
    s_sub_u32 s38, s38, 4
    buffer_load_dword v52, s[16:19], 0 offen lds
    s_mov_b32 m0, s3
    s_add_u32 s23, s23, s21
    s_cmp_lg_u32 s38, s36
    s_cbranch_scc1 L_nox
    s_mov_b32 m0, 19200
    s_add_u32 s3, s33, 215040
L_xd:
    buffer_load_dwordx4 v8, s[12:15], s3 offen offset:0 nt lds
    buffer_load_dwordx4 v9, s[12:15], s3 offen offset:1024 nt lds
    buffer_load_dwordx4 v10, s[12:15], s3 offen offset:2048 nt lds
    s_lshr_b32 exec_hi, exec_hi, 16
    buffer_load_dwordx4 v11, s[12:15], s3 offen offset:3072 nt lds
    s_mov_b32 exec_hi, -1
    s_sub_u32 s3, s3, s28
    s_sub_u32 m0, m0, 3840
    s_cbranch_scc0 L_xd
    s_add_u32 s33, s33, 258048
    s_mov_b32 m0, 70272
L_nox:
    s_cmp_gt_u32 s38, 163348
    s_cbranch_scc1 L_wl
    buffer_load_dwordx4 v44, s[16:19], s23 offen offset:0  lds
    buffer_load_dwordx4 v45, s[16:19], s23 offen offset:1024  lds
    buffer_load_dwordx4 v46, s[16:19], s23 offen offset:2048  lds
    buffer_load_dwordx4 v44, s[16:19], s23 offen offset:3072  lds
    s_addk_i32 m0, 4096
    s_addk_i32 s23, 4096
    buffer_load_dwordx4 v50, s[16:19], s23 offen offset:0  lds
    buffer_load_dwordx4 v49, s[16:19], s23 offen offset:1024  lds
    buffer_load_dwordx4 v47, s[16:19], s23 offen offset:2048  lds
    buffer_load_dwordx4 v48, s[16:19], s23 offen offset:3072  lds
    s_addk_i32 m0, 4096
    s_addk_i32 s23, 4096
    buffer_load_dwordx4 v49, s[16:19], s23 offen offset:0  lds
    buffer_load_dwordx4 v44, s[16:19], s23 offen offset:1024  lds
    buffer_load_dwordx4 v45, s[16:19], s23 offen offset:2048  lds
    buffer_load_dwordx4 v46, s[16:19], s23 offen offset:3072  lds
    s_addk_i32 m0, 4096
    s_addk_i32 s23, 4096
    buffer_load_dwordx4 v44, s[16:19], s23 offen offset:0  lds
    buffer_load_dwordx4 v50, s[16:19], s23 offen offset:1024  lds
    buffer_load_dwordx4 v49, s[16:19], s23 offen offset:2048  lds
    buffer_load_dwordx4 v47, s[16:19], s23 offen offset:3072  lds
    s_addk_i32 m0, 4096
    s_addk_i32 s23, 4096
    buffer_load_dwordx4 v48, s[16:19], s23 offen offset:0  lds
    buffer_load_dwordx4 v49, s[16:19], s23 offen offset:1024  lds
    buffer_load_dwordx4 v44, s[16:19], s23 offen offset:2048  lds
    buffer_load_dwordx4 v45, s[16:19], s23 offen offset:3072  lds
    s_addk_i32 m0, 4096
    s_addk_i32 s23, 4096
    buffer_load_dwordx4 v46, s[16:19], s23 offen offset:0  lds
    buffer_load_dwordx4 v44, s[16:19], s23 offen offset:1024  lds
    buffer_load_dwordx4 v53, s[16:19], s23 offen offset:2048  lds
    s_add_u32 s3, m0, 2688
    s_mov_b32 m0, s38
    s_sub_u32 s38, s38, 4
    buffer_load_dword v52, s[16:19], 0 offen lds
    s_mov_b32 m0, s3
    s_add_u32 s23, s23, s21
    buffer_load_dwordx4 v44, s[16:19], s23 offen offset:0  lds
    buffer_load_dwordx4 v45, s[16:19], s23 offen offset:1024  lds
    buffer_load_dwordx4 v46, s[16:19], s23 offen offset:2048  lds
    buffer_load_dwordx4 v44, s[16:19], s23 offen offset:3072  lds
    s_addk_i32 m0, 4096
    s_addk_i32 s23, 4096
    buffer_load_dwordx4 v50, s[16:19], s23 offen offset:0  lds
    buffer_load_dwordx4 v49, s[16:19], s23 offen offset:1024  lds
    buffer_load_dwordx4 v47, s[16:19], s23 offen offset:2048  lds
    buffer_load_dwordx4 v48, s[16:19], s23 offen offset:3072  lds
    s_addk_i32 m0, 4096
    s_addk_i32 s23, 4096
    buffer_load_dwordx4 v49, s[16:19], s23 offen offset:0  lds
    buffer_load_dwordx4 v44, s[16:19], s23 offen offset:1024  lds
    buffer_load_dwordx4 v45, s[16:19], s23 offen offset:2048  lds
    buffer_load_dwordx4 v46, s[16:19], s23 offen offset:3072  lds
    s_addk_i32 m0, 4096
    s_addk_i32 s23, 4096
    buffer_load_dwordx4 v44, s[16:19], s23 offen offset:0  lds
    buffer_load_dwordx4 v50, s[16:19], s23 offen offset:1024  lds
    buffer_load_dwordx4 v49, s[16:19], s23 offen offset:2048  lds
    buffer_load_dwordx4 v47, s[16:19], s23 offen offset:3072  lds
    s_addk_i32 m0, 4096
    s_addk_i32 s23, 4096
    buffer_load_dwordx4 v48, s[16:19], s23 offen offset:0  lds
    buffer_load_dwordx4 v49, s[16:19], s23 offen offset:1024  lds
    buffer_load_dwordx4 v44, s[16:19], s23 offen offset:2048  lds
    buffer_load_dwordx4 v45, s[16:19], s23 offen offset:3072  lds
    s_addk_i32 m0, 4096
    s_addk_i32 s23, 4096
    buffer_load_dwordx4 v46, s[16:19], s23 offen offset:0  lds
    buffer_load_dwordx4 v44, s[16:19], s23 offen offset:1024  lds
    buffer_load_dwordx4 v53, s[16:19], s23 offen offset:2048  lds
    s_mov_b32 m0, 23040
    s_nop 0
L_xr1:
    buffer_load_dwordx4 v8, s[12:15], s33 offen offset:0 nt lds
    buffer_load_dwordx4 v9, s[12:15], s33 offen offset:1024 nt lds
    buffer_load_dwordx4 v10, s[12:15], s33 offen offset:2048 nt lds
    buffer_load_dwordx4 v11, s[12:15], s33 offen offset:3072 nt lds
    s_addk_i32 m0, 3840
    s_add_u32 s33, s33, s28
    s_cmpk_lt_u32 m0, 30720
    s_cbranch_scc1 L_xr1
    s_cmp_lg_u32 s24, 0
    s_cselect_b32 s3, 559104, 0
    s_cselect_b32 exec_lo, 0x3fffffff, 1
    s_cselect_b32 exec_hi, 0x3fffffff, 0
    s_sub_u32 s3, s33, s3
    buffer_load_dword v5, v7, s[12:15], s3 offen nt
    s_mov_b64 exec, -1
    s_waitcnt vmcnt(9)
    s_barrier
L_xr2:
    buffer_load_dwordx4 v8, s[12:15], s33 offen offset:0 nt lds
    buffer_load_dwordx4 v9, s[12:15], s33 offen offset:1024 nt lds
    buffer_load_dwordx4 v10, s[12:15], s33 offen offset:2048 nt lds
    buffer_load_dwordx4 v11, s[12:15], s33 offen offset:3072 nt lds
    s_addk_i32 m0, 3840
    s_add_u32 s33, s33, s28
    s_cmpk_lt_u32 m0, 38400
    s_cbranch_scc1 L_xr2
    s_waitcnt vmcnt(13)
    s_barrier
    buffer_load_dwordx4 v8, s[12:15], s33 offen offset:0 nt lds
    buffer_load_dwordx4 v9, s[12:15], s33 offen offset:1024 nt lds
    buffer_load_dwordx4 v10, s[12:15], s33 offen offset:2048 nt lds
    buffer_load_dwordx4 v11, s[12:15], s33 offen offset:3072 nt lds
    s_addk_i32 m0, 3840
    s_add_u32 s33, s33, s28
    buffer_load_dwordx4 v8, s[12:15], s33 offen offset:0 nt lds
    buffer_load_dwordx4 v9, s[12:15], s33 offen offset:1024 nt lds
    buffer_load_dwordx4 v10, s[12:15], s33 offen offset:2048 nt lds
    buffer_load_dwordx4 v11, s[12:15], s33 offen offset:3072 nt lds
    s_addk_i32 m0, 3840
    s_add_u32 s33, s33, s28
    buffer_load_dwordx4 v8, s[12:15], s33 offen offset:0 nt lds
    buffer_load_dwordx4 v9, s[12:15], s33 offen offset:1024 nt lds
    buffer_load_dwordx4 v10, s[12:15], s33 offen offset:2048 nt lds
    buffer_load_dwordx4 v11, s[12:15], s33 offen offset:3072 nt lds
    s_addk_i32 m0, 3840
    s_add_u32 s33, s33, s28
    buffer_load_dwordx4 v8, s[12:15], s33 offen offset:0 nt lds
    buffer_load_dwordx4 v9, s[12:15], s33 offen offset:1024 nt lds
    buffer_load_dwordx4 v10, s[12:15], s33 offen offset:2048 nt lds
    buffer_load_dwordx4 v11, s[12:15], s33 offen offset:3072 nt lds
    s_addk_i32 m0, 3840
    s_add_u32 s33, s33, s28
    s_waitcnt vmcnt(25)
    s_barrier
    s_lshl_b32 s3, s24, 3
    s_cmp_eq_u32 s26, s3
    s_cselect_b32 s14, 0, s14
    buffer_load_dwordx4 v8, s[12:15], s33 offen offset:0 nt lds
    buffer_load_dwordx4 v9, s[12:15], s33 offen offset:1024 nt lds
    buffer_load_dwordx4 v10, s[12:15], s33 offen offset:2048 nt lds
    buffer_load_dwordx4 v11, s[12:15], s33 offen offset:3072 nt lds
    s_addk_i32 m0, 3840
    s_add_u32 s33, s33, s28
    buffer_load_dwordx4 v8, s[12:15], s33 offen offset:0 nt lds
    buffer_load_dwordx4 v9, s[12:15], s33 offen offset:1024 nt lds
    buffer_load_dwordx4 v10, s[12:15], s33 offen offset:2048 nt lds
    buffer_load_dwordx4 v11, s[12:15], s33 offen offset:3072 nt lds
    s_addk_i32 m0, 3840
    s_add_u32 s33, s33, s28
    s_cmp_lg_u32 s34, 0
    s_cselect_b32 s14, s14, 0
    buffer_load_dwordx4 v8, s[12:15], s33 offen offset:0 nt lds
    buffer_load_dwordx4 v9, s[12:15], s33 offen offset:1024 nt lds
    buffer_load_dwordx4 v10, s[12:15], s33 offen offset:2048 nt lds
    buffer_load_dwordx4 v11, s[12:15], s33 offen offset:3072 nt lds
    s_addk_i32 m0, 3840
    s_add_u32 s33, s33, s28
    s_waitcnt vmcnt(32)
    s_barrier
    s_waitcnt vmcnt(28)
    s_barrier
    s_waitcnt vmcnt(24)
    s_barrier
    s_waitcnt vmcnt(20)
    s_barrier
    s_waitcnt vmcnt(16)
    s_barrier
    s_waitcnt vmcnt(0)
    s_endpgm
L_rolecomp:
    s_and_b32 s24, s29, 1
    s_cmpk_lt_u32 s29, 224
    s_cselect_b32 s34, s24, 0
    s_sub_u32 s28, s27, 4
    s_setprio 2
    v_lshrrev_b32 v2, 4, v1
    v_and_b32 v3, 15, v1
    s_mul_i32 s30, s28, 3
    v_add_u32 v14, v3, v2
    v_bfe_u32 v15, v14, 2, 2
    v_mul_u32_u24 v14, 192, v14
    s_add_u32 s3, s30, 0
    v_xor_b32 v16, s3, v15
    v_lshl_add_u32 v4, v16, 4, v14
    s_add_u32 s3, s30, 1
    v_xor_b32 v16, s3, v15
    v_lshl_add_u32 v5, v16, 4, v14
    s_add_u32 s3, s30, 2
    v_xor_b32 v16, s3, v15
    v_lshl_add_u32 v6, v16, 4, v14
    v_add_u32 v14, 4, v3
    v_bfe_u32 v15, v14, 2, 2
    v_mul_u32_u24 v14, 192, v14
    v_add_u32 v16, s30, v2
    v_xor_b32 v16, v16, v15
    v_lshl_add_u32 v7, v16, 4, v14
    v_cmp_eq_u32 vcc, 3, v2
    v_mov_b32 v17, 262144
    s_mul_i32 s29, s28, 1152
    s_add_u32 s29, s29, 47104
    v_cndmask_b32 v7, v7, v17, vcc
    v_mul_u32_u24 v14, 4608, v2
    v_add_u32 v14, s29, v14
    v_mul_u32_u24 v15, 384, v2
    v_cndmask_b32 v15, v15, v17, vcc
    s_add_u32 s29, s29, 18432
    v_add_u32 v15, s29, v15
    v_lshlrev_b32 v16, 3, v3
    v_add_u32 v10, v15, v16
    v_add_u32 v16, v14, v16
    v_and_b32 v18, 1, v2
    v_lshl_add_u32 v8, v18, 7, v16
    v_xor_b32 v19, 1, v18
    v_lshl_add_u32 v9, v19, 7, v16
    v_bfe_u32 v16, v1, 2, 2
    v_lshlrev_b32 v16, 4, v16
    v_and_b32 v22, 1, v1
    v_lshl_add_u32 v16, v22, 3, v16
    v_add_u32 v16, 256, v16
    v_bfe_u32 v22, v1, 1, 1
    v_mul_u32_u24 v23, 262144, v22
    v_add_u32 v16, v16, v23
    v_add_u32 v21, v15, v16
    v_add_u32 v16, v14, v16
    v_lshl_add_u32 v11, v18, 6, v16
    v_lshl_add_u32 v20, v19, 6, v16
    v_mul_u32_u24 v18, 285312, v22
    v_xor_b32 v22, 1, v22
    v_mul_u32_u24 v19, 262144, v22
    v_mov_b32 v22, 163328
    v_mul_u32_u24 v14, 208, v3
    s_mul_i32 s29, s28, 48
    s_add_u32 s29, s29, 70272
    v_add_u32 v14, s29, v14
    v_lshl_add_u32 v12, v2, 3, v14
    v_and_b32 v15, 1, v2
    v_lshl_add_u32 v13, v15, 3, v14
    v_lshrrev_b32 v15, 1, v2
    v_mul_u32_u24 v15, 3328, v15
    v_add3_u32 v13, v13, v15, 32
    v_add_u32 v14, 4, v3
    v_bfe_u32 v15, v14, 2, 2
    v_mul_u32_u24 v14, 192, v14
    v_mul_u32_u24 v16, 3840, v2
    v_add_u32 v14, v14, v16
    s_add_u32 s3, s30, 0
    v_xor_b32 v16, s3, v15
    v_lshl_add_u32 v76, v16, 4, v14
    s_add_u32 s3, s30, 1
    v_xor_b32 v16, s3, v15
    v_lshl_add_u32 v77, v16, 4, v14
    s_add_u32 s3, s30, 2
    v_xor_b32 v16, s3, v15
    v_lshl_add_u32 v78, v16, 4, v14
    s_mul_i32 s3, s28, 1152
    s_add_u32 s3, s3, 65536
    v_mul_u32_u24 v14, 23168, v2
    v_add_u32 v14, s3, v14
    v_lshl_add_u32 v79, v3, 3, v14
    v_bfe_u32 v15, v1, 2, 2
    v_lshl_add_u32 v14, v15, 4, v14
    v_and_b32 v15, 1, v1
    v_lshl_add_u32 v14, v15, 3, v14
    v_bfe_u32 v15, v1, 1, 1
    v_cmp_gt_u32 vcc, v15, v2
    v_mul_u32_u24 v15, 23168, v15
    v_sub_u32 v14, v14, v15
    v_add_u32 v14, 256, v14
    v_cndmask_b32 v0, v14, v17, vcc
    v_sub_u32 v14, v19, v18
    v_add_u32 v14, 69504, v14
    v_add_u32 v2, v14, v11
    v_add_u32 v3, v14, v20
    v_add_u32 v19, v14, v21
    s_waitcnt lgkmcnt(0)
    s_mov_b32 s21, 0x40000
    s_cmp_eq_u32 s34, 0
    s_cbranch_scc1 L_go12
    s_branch L_go13
L_spin1_12:
    s_sub_u32 s21, s21, 1
    s_cbranch_scc1 L_back1_12
    ds_read_b32 v23, v22 offset:28
    s_waitcnt lgkmcnt(0)
    v_cmp_eq_u32 vcc, 0, v23
    s_cbranch_vccz L_spin1_12
    s_branch L_back1_12
L_spin2_12:
    s_sub_u32 s21, s21, 1
    s_cbranch_scc1 L_back2_12
    ds_read_b32 v23, v22 offset:24
    s_waitcnt lgkmcnt(0)
    v_cmp_eq_u32 vcc, 0, v23
    s_cbranch_vccz L_spin2_12
    s_branch L_back2_12
L_spin3_12:
    s_sub_u32 s21, s21, 1
    s_cbranch_scc1 L_back3_12
    ds_read_b32 v23, v22 offset:20
    s_waitcnt lgkmcnt(0)
    v_cmp_eq_u32 vcc, 0, v23
    s_cbranch_vccz L_spin3_12
    s_branch L_back3_12
L_spin1_13:
    s_sub_u32 s21, s21, 1
    s_cbranch_scc1 L_back1_13
    ds_read_b32 v23, v22 offset:28
    s_waitcnt lgkmcnt(0)
    v_cmp_eq_u32 vcc, 0, v23
    s_cbranch_vccz L_spin1_13
    s_branch L_back1_13
L_spin2_13:
    s_sub_u32 s21, s21, 1
    s_cbranch_scc1 L_back2_13
    ds_read_b32 v23, v22 offset:24
    s_waitcnt lgkmcnt(0)
    v_cmp_eq_u32 vcc, 0, v23
    s_cbranch_vccz L_spin2_13
    s_branch L_back2_13
L_spin3_13:
    s_sub_u32 s21, s21, 1
    s_cbranch_scc1 L_back3_13
    ds_read_b32 v23, v22 offset:20
    s_waitcnt lgkmcnt(0)
    v_cmp_eq_u32 vcc, 0, v23
    s_cbranch_vccz L_spin3_13
    s_branch L_back3_13
.p2align 12
L_go13:
    s_cbranch_execz L_padret
    s_barrier
    ds_read_b64_tr_b16 v[80:81], v8 offset:0
    ds_read_b64_tr_b16 v[82:83], v9 offset:0
    ds_read_b64_tr_b16 v[84:85], v8 offset:384
    ds_read_b64_tr_b16 v[86:87], v9 offset:384
    ds_read_b64_tr_b16 v[88:89], v8 offset:768
    ds_read_b64_tr_b16 v[90:91], v9 offset:768
    ds_read_b64_tr_b16 v[92:93], v10 offset:0
    ds_read_b64_tr_b16 v[94:95], v10 offset:128
    ds_read_b64_tr_b16 v[160:161], v11 offset:0
    ds_read_b64_tr_b16 v[162:163], v20 offset:0
    ds_read_b64_tr_b16 v[164:165], v11 offset:384
    ds_read_b64_tr_b16 v[166:167], v20 offset:384
    ds_read_b64_tr_b16 v[168:169], v11 offset:768
    ds_read_b64_tr_b16 v[170:171], v20 offset:768
    ds_read_b64_tr_b16 v[172:173], v21 offset:0
    ds_read_b64_tr_b16 v[174:175], v21 offset:64
    v_sub_u32 v11, v11, v18
    v_sub_u32 v20, v20, v18
    v_sub_u32 v21, v21, v18
    s_barrier
    ds_read_b128 v[192:195], v4 offset:0
    ds_read_b128 v[144:147], v4 offset:7680
    ds_read_b128 v[240:243], v4 offset:15360
    ds_read_b128 v[196:199], v5 offset:0
    ds_read_b128 v[148:151], v5 offset:7680
    ds_read_b128 v[244:247], v5 offset:15360
    s_waitcnt lgkmcnt(5)
    v_mfma_f32_16x16x32_bf16 v[40:43], v[80:83], v[192:195], 0
    ds_read_b128 v[200:203], v6 offset:0
    v_mfma_f32_16x16x32_bf16 v[64:67], v[160:163], v[192:195], 0
    ds_read_b128 v[152:155], v6 offset:7680
    s_waitcnt lgkmcnt(6)
    v_mfma_f32_16x16x32_bf16 v[48:51], v[80:83], v[144:147], 0
    ds_read_b128 v[248:251], v6 offset:15360
    v_mfma_f32_16x16x32_bf16 v[68:71], v[160:163], v[144:147], 0
    ds_read_b128 v[204:207], v7 offset:0
    s_waitcnt lgkmcnt(7)
    v_mfma_f32_16x16x32_bf16 v[56:59], v[80:83], v[240:243], 0
    ds_read_b128 v[156:159], v7 offset:7680
    s_waitcnt lgkmcnt(7)
    v_mfma_f32_16x16x32_bf16 v[40:43], v[84:87], v[196:199], v[40:43]
    ds_read_b128 v[252:255], v7 offset:15360
    v_mfma_f32_16x16x32_bf16 v[64:67], v[164:167], v[196:199], v[64:67]
    ds_read_b128 v[208:211], v4 offset:3840
    s_waitcnt lgkmcnt(8)
    v_mfma_f32_16x16x32_bf16 v[48:51], v[84:87], v[148:151], v[48:51]
    ds_read_b128 v[212:215], v5 offset:3840
    v_mfma_f32_16x16x32_bf16 v[68:71], v[164:167], v[148:151], v[68:71]
    ds_read_b128 v[216:219], v6 offset:3840
    s_waitcnt lgkmcnt(9)
    v_mfma_f32_16x16x32_bf16 v[56:59], v[84:87], v[244:247], v[56:59]
    ds_read_b128 v[220:223], v7 offset:3840
    s_waitcnt lgkmcnt(9)
    v_mfma_f32_16x16x32_bf16 v[40:43], v[88:91], v[200:203], v[40:43]
    ds_read_b128 v[224:227], v4 offset:11520
    v_mfma_f32_16x16x32_bf16 v[64:67], v[168:171], v[200:203], v[64:67]
    ds_read_b128 v[24:27], v4 offset:19200
    s_waitcnt lgkmcnt(10)
    v_mfma_f32_16x16x32_bf16 v[48:51], v[88:91], v[152:155], v[48:51]
    ds_read_b128 v[228:231], v5 offset:11520
    v_mfma_f32_16x16x32_bf16 v[68:71], v[168:171], v[152:155], v[68:71]
    ds_read_b128 v[28:31], v5 offset:19200
    s_waitcnt lgkmcnt(11)
    v_mfma_f32_16x16x32_bf16 v[56:59], v[88:91], v[248:251], v[56:59]
    ds_read_b128 v[232:235], v6 offset:11520
    s_waitcnt lgkmcnt(11)
    v_mfma_f32_16x16x32_bf16 v[40:43], v[92:95], v[204:207], v[40:43]
    ds_read_b128 v[32:35], v6 offset:19200
    v_mfma_f32_16x16x32_bf16 v[64:67], v[172:175], v[204:207], v[64:67]
    ds_read_b128 v[236:239], v7 offset:11520
    s_waitcnt lgkmcnt(12)
    v_mfma_f32_16x16x32_bf16 v[48:51], v[92:95], v[156:159], v[48:51]
    ds_read_b128 v[36:39], v7 offset:19200
    v_mfma_f32_16x16x32_bf16 v[68:71], v[172:175], v[156:159], v[68:71]
    s_waitcnt lgkmcnt(12)
    v_mfma_f32_16x16x32_bf16 v[56:59], v[92:95], v[252:255], v[56:59]
    v_mfma_f32_16x16x32_bf16 v[72:75], v[160:163], v[240:243], 0
    v_mfma_f32_16x16x32_bf16 v[72:75], v[164:167], v[244:247], v[72:75]
    ds_read_b32 v23, v22 offset:28
    s_waitcnt lgkmcnt(12)
    v_mfma_f32_16x16x32_bf16 v[44:47], v[80:83], v[208:211], 0
    s_waitcnt lgkmcnt(11)
    v_mfma_f32_16x16x32_bf16 v[44:47], v[84:87], v[212:215], v[44:47]
    v_mfma_f32_16x16x32_bf16 v[72:75], v[168:171], v[248:251], v[72:75]
    v_mfma_f32_16x16x32_bf16 v[72:75], v[172:175], v[252:255], v[72:75]
    s_waitcnt lgkmcnt(0)
    v_cmp_eq_u32 vcc, 0, v23
    v_mfma_f32_16x16x32_bf16 v[44:47], v[88:91], v[216:219], v[44:47]
    v_mfma_f32_16x16x32_bf16 v[44:47], v[92:95], v[220:223], v[44:47]
    s_cbranch_vccz L_spin1_13
L_back1_13:
    v_mfma_f32_16x16x32_bf16 v[52:55], v[80:83], v[224:227], 0
    ds_read_b64_tr_b16 v[96:97], v8 offset:23168
    v_mfma_f32_16x16x32_bf16 v[52:55], v[84:87], v[228:231], v[52:55]
    ds_read_b64_tr_b16 v[98:99], v9 offset:23168
    v_mfma_f32_16x16x32_bf16 v[60:63], v[80:83], v[24:27], 0
    ds_read_b64_tr_b16 v[100:101], v8 offset:23552
    v_mfma_f32_16x16x32_bf16 v[60:63], v[84:87], v[28:31], v[60:63]
    ds_read_b64_tr_b16 v[102:103], v9 offset:23552
    v_mfma_f32_16x16x32_bf16 v[52:55], v[88:91], v[232:235], v[52:55]
    ds_read_b64_tr_b16 v[104:105], v8 offset:23936
    v_mfma_f32_16x16x32_bf16 v[52:55], v[92:95], v[236:239], v[52:55]
    ds_read_b64_tr_b16 v[106:107], v9 offset:23936
    v_mfma_f32_16x16x32_bf16 v[60:63], v[88:91], v[32:35], v[60:63]
    ds_read_b64_tr_b16 v[108:109], v10 offset:23168
    v_mfma_f32_16x16x32_bf16 v[60:63], v[92:95], v[36:39], v[60:63]
    ds_read_b64_tr_b16 v[110:111], v10 offset:23296
    s_waitcnt lgkmcnt(6)
    v_mfma_f32_16x16x32_bf16 v[40:43], v[96:99], v[208:211], v[40:43]
    ds_read_b64_tr_b16 v[176:177], v11 offset:23168
    s_waitcnt lgkmcnt(5)
    v_mfma_f32_16x16x32_bf16 v[40:43], v[100:103], v[212:215], v[40:43]
    ds_read_b64_tr_b16 v[178:179], v20 offset:23168
    v_mfma_f32_16x16x32_bf16 v[44:47], v[96:99], v[144:147], v[44:47]
    ds_read_b64_tr_b16 v[180:181], v11 offset:23552
    v_mfma_f32_16x16x32_bf16 v[44:47], v[100:103], v[148:151], v[44:47]
    ds_read_b64_tr_b16 v[182:183], v20 offset:23552
    v_mfma_f32_16x16x32_bf16 v[48:51], v[96:99], v[224:227], v[48:51]
    ds_read_b64_tr_b16 v[184:185], v11 offset:23936
    v_mfma_f32_16x16x32_bf16 v[48:51], v[100:103], v[228:231], v[48:51]
    ds_read_b64_tr_b16 v[186:187], v20 offset:23936
    v_mfma_f32_16x16x32_bf16 v[52:55], v[96:99], v[240:243], v[52:55]
    ds_read_b64_tr_b16 v[188:189], v21 offset:23168
    v_mfma_f32_16x16x32_bf16 v[52:55], v[100:103], v[244:247], v[52:55]
    ds_read_b64_tr_b16 v[190:191], v21 offset:23232
    s_waitcnt lgkmcnt(10)
    v_mfma_f32_16x16x32_bf16 v[40:43], v[104:107], v[216:219], v[40:43]
    s_waitcnt lgkmcnt(8)
    v_mfma_f32_16x16x32_bf16 v[40:43], v[108:111], v[220:223], v[40:43]
    ds_read_b32 v23, v22 offset:24
    v_mfma_f32_16x16x32_bf16 v[44:47], v[104:107], v[152:155], v[44:47]
    v_mfma_f32_16x16x32_bf16 v[44:47], v[108:111], v[156:159], v[44:47]
    v_mfma_f32_16x16x32_bf16 v[48:51], v[104:107], v[232:235], v[48:51]
    v_mfma_f32_16x16x32_bf16 v[48:51], v[108:111], v[236:239], v[48:51]
    s_waitcnt lgkmcnt(0)
    v_cmp_eq_u32 vcc, 0, v23
    v_mfma_f32_16x16x32_bf16 v[52:55], v[104:107], v[248:251], v[52:55]
    v_mfma_f32_16x16x32_bf16 v[52:55], v[108:111], v[252:255], v[52:55]
    s_cbranch_vccz L_spin2_13
L_back2_13:
    v_mfma_f32_16x16x32_bf16 v[64:67], v[176:179], v[208:211], v[64:67]
    ds_read_b64_tr_b16 v[112:113], v8 offset:46336
    v_mfma_f32_16x16x32_bf16 v[64:67], v[180:183], v[212:215], v[64:67]
    ds_read_b64_tr_b16 v[114:115], v9 offset:46336
    v_mfma_f32_16x16x32_bf16 v[68:71], v[176:179], v[224:227], v[68:71]
    ds_read_b64_tr_b16 v[116:117], v8 offset:46720
    v_mfma_f32_16x16x32_bf16 v[68:71], v[180:183], v[228:231], v[68:71]
    ds_read_b64_tr_b16 v[118:119], v9 offset:46720
    v_mfma_f32_16x16x32_bf16 v[72:75], v[176:179], v[24:27], v[72:75]
    ds_read_b64_tr_b16 v[120:121], v8 offset:47104
    v_mfma_f32_16x16x32_bf16 v[72:75], v[180:183], v[28:31], v[72:75]
    ds_read_b64_tr_b16 v[122:123], v9 offset:47104
    v_mfma_f32_16x16x32_bf16 v[56:59], v[96:99], v[24:27], v[56:59]
    ds_read_b64_tr_b16 v[124:125], v10 offset:46336
    v_mfma_f32_16x16x32_bf16 v[56:59], v[100:103], v[28:31], v[56:59]
    ds_read_b64_tr_b16 v[126:127], v10 offset:46464
    v_mfma_f32_16x16x32_bf16 v[64:67], v[184:187], v[216:219], v[64:67]
    v_add_u32 v8, 69504, v8
    v_mfma_f32_16x16x32_bf16 v[64:67], v[188:191], v[220:223], v[64:67]
    v_add_u32 v9, 69504, v9
    v_mfma_f32_16x16x32_bf16 v[68:71], v[184:187], v[232:235], v[68:71]
    v_add_u32 v10, 69504, v10
    v_mfma_f32_16x16x32_bf16 v[68:71], v[188:191], v[236:239], v[68:71]
    ds_read_b64_tr_b16 v[192:193], v11 offset:46336
    v_mfma_f32_16x16x32_bf16 v[72:75], v[184:187], v[32:35], v[72:75]
    ds_read_b64_tr_b16 v[194:195], v20 offset:46336
    v_mfma_f32_16x16x32_bf16 v[72:75], v[188:191], v[36:39], v[72:75]
    ds_read_b64_tr_b16 v[196:197], v11 offset:46720
    v_mfma_f32_16x16x32_bf16 v[56:59], v[104:107], v[32:35], v[56:59]
    ds_read_b64_tr_b16 v[198:199], v20 offset:46720
    v_mfma_f32_16x16x32_bf16 v[56:59], v[108:111], v[36:39], v[56:59]
    ds_read_b64_tr_b16 v[200:201], v11 offset:47104
    s_waitcnt lgkmcnt(11)
    v_mfma_f32_16x16x32_bf16 v[40:43], v[112:115], v[144:147], v[40:43]
    ds_read_b64_tr_b16 v[202:203], v20 offset:47104
    s_waitcnt lgkmcnt(10)
    v_mfma_f32_16x16x32_bf16 v[40:43], v[116:119], v[148:151], v[40:43]
    ds_read_b32 v23, v22 offset:20
    v_mfma_f32_16x16x32_bf16 v[44:47], v[112:115], v[224:227], v[44:47]
    ds_read_b64_tr_b16 v[204:205], v21 offset:46336
    v_mfma_f32_16x16x32_bf16 v[44:47], v[116:119], v[228:231], v[44:47]
    ds_read_b64_tr_b16 v[206:207], v21 offset:46400
    s_waitcnt lgkmcnt(11)
    v_mfma_f32_16x16x32_bf16 v[40:43], v[120:123], v[152:155], v[40:43]
    v_add_u32 v11, 69504, v11
    s_waitcnt lgkmcnt(9)
    v_mfma_f32_16x16x32_bf16 v[40:43], v[124:127], v[156:159], v[40:43]
    v_add_u32 v20, 69504, v20
    v_mfma_f32_16x16x32_bf16 v[44:47], v[120:123], v[232:235], v[44:47]
    v_add_u32 v21, 69504, v21
    v_mfma_f32_16x16x32_bf16 v[44:47], v[124:127], v[236:239], v[44:47]
    s_waitcnt lgkmcnt(2)
    v_cmp_eq_u32 vcc, 0, v23
    v_mfma_f32_16x16x32_bf16 v[64:67], v[192:195], v[144:147], v[64:67]
    s_cbranch_vccz L_spin3_13
L_back3_13:
    v_mfma_f32_16x16x32_bf16 v[64:67], v[196:199], v[148:151], v[64:67]
    ds_read_b64_tr_b16 v[128:129], v8 offset:0
    v_mfma_f32_16x16x32_bf16 v[68:71], v[192:195], v[240:243], v[68:71]
    ds_read_b64_tr_b16 v[130:131], v9 offset:0
    v_mfma_f32_16x16x32_bf16 v[68:71], v[196:199], v[244:247], v[68:71]
    ds_read_b64_tr_b16 v[132:133], v8 offset:384
    v_mfma_f32_16x16x32_bf16 v[48:51], v[112:115], v[240:243], v[48:51]
    ds_read_b64_tr_b16 v[134:135], v9 offset:384
    v_mfma_f32_16x16x32_bf16 v[48:51], v[116:119], v[244:247], v[48:51]
    ds_read_b64_tr_b16 v[136:137], v8 offset:768
    v_mfma_f32_16x16x32_bf16 v[52:55], v[112:115], v[24:27], v[52:55]
    ds_read_b64_tr_b16 v[138:139], v9 offset:768
    v_mfma_f32_16x16x32_bf16 v[52:55], v[116:119], v[28:31], v[52:55]
    ds_read_b64_tr_b16 v[140:141], v10 offset:0
    v_mfma_f32_16x16x32_bf16 v[64:67], v[200:203], v[152:155], v[64:67]
    ds_read_b64_tr_b16 v[142:143], v10 offset:128
    s_waitcnt lgkmcnt(8)
    v_mfma_f32_16x16x32_bf16 v[64:67], v[204:207], v[156:159], v[64:67]
    ds_read_b64_tr_b16 v[208:209], v11 offset:0
    v_mfma_f32_16x16x32_bf16 v[68:71], v[200:203], v[248:251], v[68:71]
    ds_read_b64_tr_b16 v[210:211], v20 offset:0
    v_mfma_f32_16x16x32_bf16 v[68:71], v[204:207], v[252:255], v[68:71]
    ds_read_b64_tr_b16 v[212:213], v11 offset:384
    v_mfma_f32_16x16x32_bf16 v[48:51], v[120:123], v[248:251], v[48:51]
    ds_read_b64_tr_b16 v[214:215], v20 offset:384
    v_mfma_f32_16x16x32_bf16 v[48:51], v[124:127], v[252:255], v[48:51]
    ds_read_b64_tr_b16 v[216:217], v11 offset:768
    v_mfma_f32_16x16x32_bf16 v[52:55], v[120:123], v[32:35], v[52:55]
    ds_read_b64_tr_b16 v[218:219], v20 offset:768
    v_mfma_f32_16x16x32_bf16 v[52:55], v[124:127], v[36:39], v[52:55]
    ds_read_b64_tr_b16 v[220:221], v21 offset:0
    s_waitcnt lgkmcnt(13)
    v_mfma_f32_16x16x32_bf16 v[40:43], v[128:131], v[224:227], v[40:43]
    ds_read_b64_tr_b16 v[222:223], v21 offset:64
    s_waitcnt lgkmcnt(12)
    v_mfma_f32_16x16x32_bf16 v[40:43], v[132:135], v[228:231], v[40:43]
    s_waitcnt lgkmcnt(10)
    v_mfma_f32_16x16x32_bf16 v[40:43], v[136:139], v[232:235], v[40:43]
    s_waitcnt lgkmcnt(8)
    v_mfma_f32_16x16x32_bf16 v[40:43], v[140:143], v[236:239], v[40:43]
    s_barrier
    s_waitcnt lgkmcnt(6)
    v_mfma_f32_16x16x32_bf16 v[64:67], v[208:211], v[224:227], v[64:67]
    ds_read_b64_tr_b16 v[144:145], v8 offset:23168
    s_waitcnt lgkmcnt(5)
    v_mfma_f32_16x16x32_bf16 v[64:67], v[212:215], v[228:231], v[64:67]
    ds_read_b64_tr_b16 v[146:147], v9 offset:23168
    v_mfma_f32_16x16x32_bf16 v[44:47], v[128:131], v[240:243], v[44:47]
    ds_read_b64_tr_b16 v[148:149], v8 offset:23552
    v_mfma_f32_16x16x32_bf16 v[44:47], v[132:135], v[244:247], v[44:47]
    ds_read_b64_tr_b16 v[150:151], v9 offset:23552
    s_waitcnt lgkmcnt(6)
    v_mfma_f32_16x16x32_bf16 v[64:67], v[216:219], v[232:235], v[64:67]
    ds_read_b64_tr_b16 v[152:153], v8 offset:23936
    s_waitcnt lgkmcnt(5)
    v_mfma_f32_16x16x32_bf16 v[64:67], v[220:223], v[236:239], v[64:67]
    ds_read_b64_tr_b16 v[154:155], v9 offset:23936
    v_mfma_f32_16x16x32_bf16 v[44:47], v[136:139], v[248:251], v[44:47]
    ds_read_b64_tr_b16 v[156:157], v10 offset:23168
    v_mfma_f32_16x16x32_bf16 v[44:47], v[140:143], v[252:255], v[44:47]
    ds_read_b64_tr_b16 v[158:159], v10 offset:23296
    v_mfma_f32_16x16x32_bf16 v[48:51], v[128:131], v[24:27], v[48:51]
    ds_read_b64_tr_b16 v[224:225], v11 offset:23168
    v_mfma_f32_16x16x32_bf16 v[48:51], v[132:135], v[28:31], v[48:51]
    ds_read_b64_tr_b16 v[226:227], v20 offset:23168
    s_waitcnt lgkmcnt(8)
    v_mfma_f32_16x16x32_bf16 v[40:43], v[144:147], v[240:243], v[40:43]
    ds_read_b64_tr_b16 v[228:229], v11 offset:23552
    s_waitcnt lgkmcnt(7)
    v_mfma_f32_16x16x32_bf16 v[40:43], v[148:151], v[244:247], v[40:43]
    ds_read_b64_tr_b16 v[230:231], v20 offset:23552
    v_mfma_f32_16x16x32_bf16 v[48:51], v[136:139], v[32:35], v[48:51]
    ds_read_b64_tr_b16 v[232:233], v11 offset:23936
    v_mfma_f32_16x16x32_bf16 v[48:51], v[140:143], v[36:39], v[48:51]
    ds_read_b64_tr_b16 v[234:235], v20 offset:23936
    s_waitcnt lgkmcnt(8)
    v_mfma_f32_16x16x32_bf16 v[40:43], v[152:155], v[248:251], v[40:43]
    ds_read_b64_tr_b16 v[236:237], v21 offset:23168
    s_waitcnt lgkmcnt(7)
    v_mfma_f32_16x16x32_bf16 v[40:43], v[156:159], v[252:255], v[40:43]
    ds_read_b64_tr_b16 v[238:239], v21 offset:23232
    s_waitcnt lgkmcnt(6)
    v_mfma_f32_16x16x32_bf16 v[64:67], v[224:227], v[240:243], v[64:67]
    ds_read_b64_tr_b16 v[240:241], v2 offset:46336
    s_waitcnt lgkmcnt(5)
    v_mfma_f32_16x16x32_bf16 v[64:67], v[228:231], v[244:247], v[64:67]
    ds_read_b64_tr_b16 v[242:243], v3 offset:46336
    v_mfma_f32_16x16x32_bf16 v[68:71], v[208:211], v[24:27], v[68:71]
    ds_read_b64_tr_b16 v[244:245], v2 offset:46720
    v_mfma_f32_16x16x32_bf16 v[68:71], v[212:215], v[28:31], v[68:71]
    ds_read_b64_tr_b16 v[246:247], v3 offset:46720
    s_waitcnt lgkmcnt(6)
    v_mfma_f32_16x16x32_bf16 v[64:67], v[232:235], v[248:251], v[64:67]
    ds_read_b64_tr_b16 v[248:249], v2 offset:47104
    s_waitcnt lgkmcnt(5)
    v_mfma_f32_16x16x32_bf16 v[64:67], v[236:239], v[252:255], v[64:67]
    ds_read_b64_tr_b16 v[250:251], v3 offset:47104
    v_mfma_f32_16x16x32_bf16 v[68:71], v[216:219], v[32:35], v[68:71]
    ds_read_b64_tr_b16 v[252:253], v19 offset:46336
    v_mfma_f32_16x16x32_bf16 v[68:71], v[220:223], v[36:39], v[68:71]
    ds_read_b64_tr_b16 v[254:255], v19 offset:46400
    v_mfma_f32_16x16x32_bf16 v[44:47], v[144:147], v[24:27], v[44:47]
    s_barrier
    v_mfma_f32_16x16x32_bf16 v[44:47], v[148:151], v[28:31], v[44:47]
    v_cvt_pk_bf16_f32 v8, v40, v41
    s_waitcnt lgkmcnt(6)
    v_mfma_f32_16x16x32_bf16 v[64:67], v[240:243], v[24:27], v[64:67]
    ds_read_b128 v[24:27], v4 offset:23040
    s_waitcnt lgkmcnt(5)
    v_mfma_f32_16x16x32_bf16 v[64:67], v[244:247], v[28:31], v[64:67]
    ds_read_b128 v[28:31], v5 offset:23040
    v_mfma_f32_16x16x32_bf16 v[44:47], v[152:155], v[32:35], v[44:47]
    v_cvt_pk_bf16_f32 v9, v42, v43
    v_mfma_f32_16x16x32_bf16 v[44:47], v[156:159], v[36:39], v[44:47]
    s_nop 1
    s_waitcnt lgkmcnt(4)
    v_mfma_f32_16x16x32_bf16 v[64:67], v[248:251], v[32:35], v[64:67]
    ds_read_b128 v[32:35], v6 offset:23040
    s_waitcnt lgkmcnt(3)
    v_mfma_f32_16x16x32_bf16 v[64:67], v[252:255], v[36:39], v[64:67]
    ds_read_b128 v[36:39], v7 offset:23040
    s_waitcnt lgkmcnt(3)
    v_mfma_f32_16x16x32_bf16 v[48:51], v[144:147], v[24:27], v[48:51]
    v_cvt_pk_bf16_f32 v44, v44, v45
    s_waitcnt lgkmcnt(2)
    v_mfma_f32_16x16x32_bf16 v[48:51], v[148:151], v[28:31], v[48:51]
    v_cvt_pk_bf16_f32 v45, v46, v47
    v_mfma_f32_16x16x32_bf16 v[68:71], v[224:227], v[24:27], v[68:71]
    v_cvt_pk_bf16_f32 v46, v64, v65
    v_mfma_f32_16x16x32_bf16 v[68:71], v[228:231], v[28:31], v[68:71]
    v_cvt_pk_bf16_f32 v47, v66, v67
    v_mfma_f32_16x16x32_bf16 v[52:55], v[128:131], v[24:27], v[52:55]
    v_mfma_f32_16x16x32_bf16 v[52:55], v[132:135], v[28:31], v[52:55]
    v_mfma_f32_16x16x32_bf16 v[56:59], v[112:115], v[24:27], v[56:59]
    v_mfma_f32_16x16x32_bf16 v[56:59], v[116:119], v[28:31], v[56:59]
    v_mfma_f32_16x16x32_bf16 v[60:63], v[96:99], v[24:27], v[60:63]
    v_mfma_f32_16x16x32_bf16 v[60:63], v[100:103], v[28:31], v[60:63]
    v_mfma_f32_16x16x32_bf16 v[40:43], v[80:83], v[24:27], 0
    v_mfma_f32_16x16x32_bf16 v[40:43], v[84:87], v[28:31], v[40:43]
    v_mfma_f32_16x16x32_bf16 v[72:75], v[192:195], v[24:27], v[72:75]
    v_mfma_f32_16x16x32_bf16 v[72:75], v[196:199], v[28:31], v[72:75]
    s_barrier
    v_mfma_f32_16x16x32_bf16 v[64:67], v[160:163], v[24:27], 0
    v_mfma_f32_16x16x32_bf16 v[64:67], v[164:167], v[28:31], v[64:67]
    ds_read_b128 v[24:27], v4 offset:26880
    s_waitcnt lgkmcnt(2)
    v_mfma_f32_16x16x32_bf16 v[48:51], v[152:155], v[32:35], v[48:51]
    ds_read_b128 v[28:31], v5 offset:26880
    s_waitcnt lgkmcnt(2)
    v_mfma_f32_16x16x32_bf16 v[48:51], v[156:159], v[36:39], v[48:51]
    v_mov_b32 v2, v76
    v_mfma_f32_16x16x32_bf16 v[68:71], v[232:235], v[32:35], v[68:71]
    v_mov_b32 v3, v77
    v_mfma_f32_16x16x32_bf16 v[68:71], v[236:239], v[36:39], v[68:71]
    v_mov_b32 v19, v78
    v_mfma_f32_16x16x32_bf16 v[52:55], v[136:139], v[32:35], v[52:55]
    v_mov_b32 v18, v79
    v_mfma_f32_16x16x32_bf16 v[52:55], v[140:143], v[36:39], v[52:55]
    v_cvt_pk_bf16_f32 v10, v48, v49
    v_mfma_f32_16x16x32_bf16 v[56:59], v[120:123], v[32:35], v[56:59]
    v_cvt_pk_bf16_f32 v11, v50, v51
    v_mfma_f32_16x16x32_bf16 v[56:59], v[124:127], v[36:39], v[56:59]
    v_mfma_f32_16x16x32_bf16 v[60:63], v[104:107], v[32:35], v[60:63]
    v_mfma_f32_16x16x32_bf16 v[60:63], v[108:111], v[36:39], v[60:63]
    v_mfma_f32_16x16x32_bf16 v[40:43], v[88:91], v[32:35], v[40:43]
    v_mfma_f32_16x16x32_bf16 v[40:43], v[92:95], v[36:39], v[40:43]
    v_mfma_f32_16x16x32_bf16 v[72:75], v[200:203], v[32:35], v[72:75]
    v_mfma_f32_16x16x32_bf16 v[72:75], v[204:207], v[36:39], v[72:75]
    v_mfma_f32_16x16x32_bf16 v[64:67], v[168:171], v[32:35], v[64:67]
    v_mfma_f32_16x16x32_bf16 v[64:67], v[172:175], v[36:39], v[64:67]
    ds_read_b128 v[32:35], v6 offset:26880
    s_waitcnt lgkmcnt(2)
    v_mfma_f32_16x16x32_bf16 v[52:55], v[144:147], v[24:27], v[52:55]
    ds_read_b128 v[36:39], v7 offset:26880
    s_waitcnt lgkmcnt(2)
    v_mfma_f32_16x16x32_bf16 v[52:55], v[148:151], v[28:31], v[52:55]
    v_mfma_f32_16x16x32_bf16 v[68:71], v[240:243], v[24:27], v[68:71]
    v_mfma_f32_16x16x32_bf16 v[68:71], v[244:247], v[28:31], v[68:71]
    v_mfma_f32_16x16x32_bf16 v[56:59], v[128:131], v[24:27], v[56:59]
    v_mfma_f32_16x16x32_bf16 v[56:59], v[132:135], v[28:31], v[56:59]
    v_mfma_f32_16x16x32_bf16 v[60:63], v[112:115], v[24:27], v[60:63]
    v_mfma_f32_16x16x32_bf16 v[60:63], v[116:119], v[28:31], v[60:63]
    v_mfma_f32_16x16x32_bf16 v[40:43], v[96:99], v[24:27], v[40:43]
    v_mfma_f32_16x16x32_bf16 v[40:43], v[100:103], v[28:31], v[40:43]
    v_mfma_f32_16x16x32_bf16 v[48:51], v[80:83], v[24:27], 0
    v_mfma_f32_16x16x32_bf16 v[48:51], v[84:87], v[28:31], v[48:51]
    v_mfma_f32_16x16x32_bf16 v[72:75], v[208:211], v[24:27], v[72:75]
    v_mfma_f32_16x16x32_bf16 v[72:75], v[212:215], v[28:31], v[72:75]
    s_barrier
    v_mfma_f32_16x16x32_bf16 v[64:67], v[176:179], v[24:27], v[64:67]
    v_mfma_f32_16x16x32_bf16 v[64:67], v[180:183], v[28:31], v[64:67]
    ds_read_b128 v[24:27], v4 offset:30720
    s_waitcnt lgkmcnt(2)
    v_mfma_f32_16x16x32_bf16 v[52:55], v[152:155], v[32:35], v[52:55]
    ds_read_b128 v[28:31], v5 offset:30720
    s_waitcnt lgkmcnt(2)
    v_mfma_f32_16x16x32_bf16 v[52:55], v[156:159], v[36:39], v[52:55]
    s_nop 1
    v_mfma_f32_16x16x32_bf16 v[68:71], v[248:251], v[32:35], v[68:71]
    s_nop 1
    v_mfma_f32_16x16x32_bf16 v[68:71], v[252:255], v[36:39], v[68:71]
    s_nop 0
    v_mfma_f32_16x16x32_bf16 v[56:59], v[136:139], v[32:35], v[56:59]
    v_cvt_pk_bf16_f32 v20, v52, v53
    v_mfma_f32_16x16x32_bf16 v[56:59], v[140:143], v[36:39], v[56:59]
    v_cvt_pk_bf16_f32 v21, v54, v55
    v_mfma_f32_16x16x32_bf16 v[60:63], v[120:123], v[32:35], v[60:63]
    s_nop 0
    v_mfma_f32_16x16x32_bf16 v[60:63], v[124:127], v[36:39], v[60:63]
    v_cvt_pk_bf16_f32 v14, v68, v69
    v_mfma_f32_16x16x32_bf16 v[40:43], v[104:107], v[32:35], v[40:43]
    v_cvt_pk_bf16_f32 v15, v70, v71
    v_mfma_f32_16x16x32_bf16 v[40:43], v[108:111], v[36:39], v[40:43]
    v_mfma_f32_16x16x32_bf16 v[48:51], v[88:91], v[32:35], v[48:51]
    v_mfma_f32_16x16x32_bf16 v[48:51], v[92:95], v[36:39], v[48:51]
    v_mfma_f32_16x16x32_bf16 v[72:75], v[216:219], v[32:35], v[72:75]
    v_mfma_f32_16x16x32_bf16 v[72:75], v[220:223], v[36:39], v[72:75]
    v_mfma_f32_16x16x32_bf16 v[64:67], v[184:187], v[32:35], v[64:67]
    v_mfma_f32_16x16x32_bf16 v[64:67], v[188:191], v[36:39], v[64:67]
    ds_read_b128 v[32:35], v6 offset:30720
    s_waitcnt lgkmcnt(2)
    v_mfma_f32_16x16x32_bf16 v[56:59], v[144:147], v[24:27], v[56:59]
    ds_read_b128 v[36:39], v7 offset:30720
    s_waitcnt lgkmcnt(2)
    v_mfma_f32_16x16x32_bf16 v[56:59], v[148:151], v[28:31], v[56:59]
    ds_read_b64_tr_b16 v[108:109], v18 offset:23168
    v_mfma_f32_16x16x32_bf16 v[72:75], v[224:227], v[24:27], v[72:75]
    ds_read_b64_tr_b16 v[110:111], v18 offset:23296
    v_mfma_f32_16x16x32_bf16 v[72:75], v[228:231], v[28:31], v[72:75]
    ds_read_b64_tr_b16 v[172:173], v18 offset:0
    v_mfma_f32_16x16x32_bf16 v[60:63], v[128:131], v[24:27], v[60:63]
    ds_read_b64_tr_b16 v[174:175], v18 offset:128
    v_mfma_f32_16x16x32_bf16 v[60:63], v[132:135], v[28:31], v[60:63]
    ds_read_b64_tr_b16 v[188:189], v0 offset:0
    v_mfma_f32_16x16x32_bf16 v[40:43], v[112:115], v[24:27], v[40:43]
    ds_read_b64_tr_b16 v[190:191], v0 offset:64
    v_mfma_f32_16x16x32_bf16 v[40:43], v[116:119], v[28:31], v[40:43]
    ds_read_b64_tr_b16 v[76:77], v18 offset:23552
    v_mfma_f32_16x16x32_bf16 v[48:51], v[96:99], v[24:27], v[48:51]
    ds_read_b64_tr_b16 v[78:79], v18 offset:23680
    v_mfma_f32_16x16x32_bf16 v[48:51], v[100:103], v[28:31], v[48:51]
    v_mfma_f32_16x16x32_bf16 v[52:55], v[80:83], v[24:27], 0
    v_mfma_f32_16x16x32_bf16 v[52:55], v[84:87], v[28:31], v[52:55]
    v_mfma_f32_16x16x32_bf16 v[64:67], v[192:195], v[24:27], v[64:67]
    v_mfma_f32_16x16x32_bf16 v[64:67], v[196:199], v[28:31], v[64:67]
    s_barrier
    v_mfma_f32_16x16x32_bf16 v[68:71], v[160:163], v[24:27], 0
    v_mfma_f32_16x16x32_bf16 v[68:71], v[164:167], v[28:31], v[68:71]
    ds_read_b128 v[24:27], v4 offset:34560
    s_waitcnt lgkmcnt(10)
    v_mfma_f32_16x16x32_bf16 v[56:59], v[152:155], v[32:35], v[56:59]
    ds_read_b128 v[28:31], v5 offset:34560
    s_waitcnt lgkmcnt(10)
    v_mfma_f32_16x16x32_bf16 v[56:59], v[156:159], v[36:39], v[56:59]
    s_nop 1
    v_mfma_f32_16x16x32_bf16 v[72:75], v[232:235], v[32:35], v[72:75]
    s_nop 1
    v_mfma_f32_16x16x32_bf16 v[72:75], v[236:239], v[36:39], v[72:75]
    s_nop 0
    v_mfma_f32_16x16x32_bf16 v[60:63], v[136:139], v[32:35], v[60:63]
    v_cvt_pk_bf16_f32 v16, v56, v57
    v_mfma_f32_16x16x32_bf16 v[60:63], v[140:143], v[36:39], v[60:63]
    v_cvt_pk_bf16_f32 v17, v58, v59
    v_mfma_f32_16x16x32_bf16 v[40:43], v[120:123], v[32:35], v[40:43]
    v_mfma_f32_16x16x32_bf16 v[40:43], v[124:127], v[36:39], v[40:43]
    v_mfma_f32_16x16x32_bf16 v[48:51], v[104:107], v[32:35], v[48:51]
    v_mfma_f32_16x16x32_bf16 v[52:55], v[88:91], v[32:35], v[52:55]
    v_mfma_f32_16x16x32_bf16 v[64:67], v[200:203], v[32:35], v[64:67]
    v_mfma_f32_16x16x32_bf16 v[64:67], v[204:207], v[36:39], v[64:67]
    v_mfma_f32_16x16x32_bf16 v[68:71], v[168:171], v[32:35], v[68:71]
    ds_read_b128 v[36:39], v7 offset:34560
    s_waitcnt lgkmcnt(2)
    v_mfma_f32_16x16x32_bf16 v[60:63], v[144:147], v[24:27], v[60:63]
    ds_read_b128 v[32:35], v6 offset:34560
    s_waitcnt lgkmcnt(2)
    v_mfma_f32_16x16x32_bf16 v[60:63], v[148:151], v[28:31], v[60:63]
    ds_write_b32 v12, v8 offset:0
    v_mfma_f32_16x16x32_bf16 v[72:75], v[240:243], v[24:27], v[72:75]
    ds_write_b32 v12, v9 offset:4
    v_mfma_f32_16x16x32_bf16 v[72:75], v[244:247], v[28:31], v[72:75]
    ds_write_b32 v12, v44 offset:3328
    v_mfma_f32_16x16x32_bf16 v[40:43], v[128:131], v[24:27], v[40:43]
    ds_write_b32 v12, v45 offset:3332
    v_mfma_f32_16x16x32_bf16 v[40:43], v[132:135], v[28:31], v[40:43]
    ds_write_b32 v13, v46 offset:0
    v_mfma_f32_16x16x32_bf16 v[48:51], v[112:115], v[24:27], v[48:51]
    ds_write_b32 v13, v47 offset:4
    v_mfma_f32_16x16x32_bf16 v[48:51], v[116:119], v[28:31], v[48:51]
    ds_write_b32 v12, v10 offset:6656
    v_mfma_f32_16x16x32_bf16 v[52:55], v[96:99], v[24:27], v[52:55]
    ds_write_b32 v12, v11 offset:6660
    v_mfma_f32_16x16x32_bf16 v[52:55], v[100:103], v[28:31], v[52:55]
    ds_write_b32 v12, v20 offset:9984
    v_mfma_f32_16x16x32_bf16 v[56:59], v[80:83], v[24:27], 0
    ds_write_b32 v12, v21 offset:9988
    v_mfma_f32_16x16x32_bf16 v[56:59], v[84:87], v[28:31], v[56:59]
    ds_write_b32 v13, v14 offset:6656
    v_mfma_f32_16x16x32_bf16 v[64:67], v[208:211], v[24:27], v[64:67]
    ds_write_b32 v13, v15 offset:6660
    v_mfma_f32_16x16x32_bf16 v[64:67], v[212:215], v[28:31], v[64:67]
    s_barrier
    v_mfma_f32_16x16x32_bf16 v[68:71], v[176:179], v[24:27], v[68:71]
    ds_write_b32 v12, v16 offset:23168
    v_mfma_f32_16x16x32_bf16 v[68:71], v[180:183], v[28:31], v[68:71]
    ds_read_b128 v[24:27], v4 offset:38400
    s_waitcnt lgkmcnt(14)
    v_mfma_f32_16x16x32_bf16 v[60:63], v[152:155], v[32:35], v[60:63]
    ds_read_b128 v[28:31], v5 offset:38400
    v_mfma_f32_16x16x32_bf16 v[60:63], v[156:159], v[36:39], v[60:63]
    ds_write_b32 v12, v17 offset:23172
    v_mfma_f32_16x16x32_bf16 v[72:75], v[248:251], v[32:35], v[72:75]
    s_nop 1
    v_mfma_f32_16x16x32_bf16 v[72:75], v[252:255], v[36:39], v[72:75]
    s_nop 1
    v_mfma_f32_16x16x32_bf16 v[40:43], v[136:139], v[32:35], v[40:43]
    v_cvt_pk_bf16_f32 v14, v60, v61
    v_mfma_f32_16x16x32_bf16 v[40:43], v[140:143], v[36:39], v[40:43]
    v_cvt_pk_bf16_f32 v15, v62, v63
    v_mfma_f32_16x16x32_bf16 v[48:51], v[120:123], v[32:35], v[48:51]
    ds_write_b32 v12, v14 offset:26496
    v_mfma_f32_16x16x32_bf16 v[52:55], v[104:107], v[32:35], v[52:55]
    ds_write_b32 v12, v15 offset:26500
    v_mfma_f32_16x16x32_bf16 v[56:59], v[88:91], v[32:35], v[56:59]
    v_cvt_pk_bf16_f32 v16, v72, v73
    v_mfma_f32_16x16x32_bf16 v[56:59], v[92:95], v[36:39], v[56:59]
    v_cvt_pk_bf16_f32 v17, v74, v75
    v_mfma_f32_16x16x32_bf16 v[64:67], v[216:219], v[32:35], v[64:67]
    ds_write_b32 v13, v16 offset:23168
    v_mfma_f32_16x16x32_bf16 v[64:67], v[220:223], v[36:39], v[64:67]
    ds_write_b32 v13, v17 offset:23172
    v_mfma_f32_16x16x32_bf16 v[68:71], v[184:187], v[32:35], v[68:71]
    ds_read_b128 v[36:39], v7 offset:38400
    s_waitcnt lgkmcnt(7)
    v_mfma_f32_16x16x32_bf16 v[40:43], v[144:147], v[24:27], v[40:43]
    ds_read_b128 v[32:35], v6 offset:38400
    s_waitcnt lgkmcnt(7)
    v_mfma_f32_16x16x32_bf16 v[40:43], v[148:151], v[28:31], v[40:43]
    v_mfma_f32_16x16x32_bf16 v[64:67], v[224:227], v[24:27], v[64:67]
    v_mfma_f32_16x16x32_bf16 v[64:67], v[228:231], v[28:31], v[64:67]
    v_mfma_f32_16x16x32_bf16 v[48:51], v[128:131], v[24:27], v[48:51]
    v_mfma_f32_16x16x32_bf16 v[48:51], v[132:135], v[28:31], v[48:51]
    s_waitcnt lgkmcnt(2)
    s_barrier
    v_mfma_f32_16x16x32_bf16 v[52:55], v[112:115], v[24:27], v[52:55]
    ds_read_b64_tr_b16 v[44:45], v18 offset:384
    v_mfma_f32_16x16x32_bf16 v[52:55], v[116:119], v[28:31], v[52:55]
    ds_read_b64_tr_b16 v[46:47], v18 offset:512
    v_mfma_f32_16x16x32_bf16 v[56:59], v[96:99], v[24:27], v[56:59]
    ds_read_b64_tr_b16 v[124:125], v0 offset:384
    v_mfma_f32_16x16x32_bf16 v[56:59], v[100:103], v[28:31], v[56:59]
    ds_read_b64_tr_b16 v[126:127], v0 offset:448
    v_mfma_f32_16x16x32_bf16 v[60:63], v[80:83], v[24:27], 0
    ds_read_b64_tr_b16 v[204:205], v18 offset:23936
    v_mfma_f32_16x16x32_bf16 v[60:63], v[84:87], v[28:31], v[60:63]
    ds_read_b64_tr_b16 v[206:207], v18 offset:24064
    v_mfma_f32_16x16x32_bf16 v[68:71], v[192:195], v[24:27], v[68:71]
    ds_read_b64_tr_b16 v[140:141], v18 offset:768
    v_mfma_f32_16x16x32_bf16 v[68:71], v[196:199], v[28:31], v[68:71]
    ds_read_b64_tr_b16 v[142:143], v18 offset:896
    v_mfma_f32_16x16x32_bf16 v[72:75], v[160:163], v[24:27], 0
    ds_read_b64_tr_b16 v[220:221], v0 offset:768
    v_mfma_f32_16x16x32_bf16 v[72:75], v[164:167], v[28:31], v[72:75]
    ds_read_b64_tr_b16 v[222:223], v0 offset:832
    s_waitcnt lgkmcnt(10)
    v_mfma_f32_16x16x32_bf16 v[40:43], v[152:155], v[32:35], v[40:43]
    ds_read_b128 v[24:27], v4 offset:42240
L_padb:
    s_cbranch_execz L_padret
    v_mfma_f32_16x16x32_bf16 v[40:43], v[156:159], v[36:39], v[40:43]
    ds_read_b128 v[28:31], v5 offset:42240
    v_mfma_f32_16x16x32_bf16 v[64:67], v[232:235], v[32:35], v[64:67]
    ds_read_b128 v[8:11], v2 offset:30720
    v_mfma_f32_16x16x32_bf16 v[64:67], v[236:239], v[36:39], v[64:67]
    ds_read_b128 v[20:23], v3 offset:30720
    v_mfma_f32_16x16x32_bf16 v[48:51], v[136:139], v[32:35], v[48:51]
    ds_read_b128 v[36:39], v7 offset:42240
    v_mfma_f32_16x16x32_bf16 v[52:55], v[120:123], v[32:35], v[52:55]
    v_cvt_pk_bf16_f32 v14, v40, v41
    v_mfma_f32_16x16x32_bf16 v[56:59], v[104:107], v[32:35], v[56:59]
    v_cvt_pk_bf16_f32 v15, v42, v43
    v_mfma_f32_16x16x32_bf16 v[60:63], v[88:91], v[32:35], v[60:63]
    ds_write_b32 v12, v14 offset:29824
    v_mfma_f32_16x16x32_bf16 v[68:71], v[200:203], v[32:35], v[68:71]
    ds_write_b32 v12, v15 offset:29828
    v_mfma_f32_16x16x32_bf16 v[72:75], v[168:171], v[32:35], v[72:75]
    s_waitcnt lgkmcnt(4)
    v_mfma_f32_16x16x32_bf16 v[48:51], v[108:111], v[8:11], v[48:51]
    ds_read_b128 v[32:35], v6 offset:42240
    s_waitcnt lgkmcnt(4)
    v_mfma_f32_16x16x32_bf16 v[48:51], v[76:79], v[20:23], v[48:51]
    v_mfma_f32_16x16x32_bf16 v[52:55], v[172:175], v[8:11], v[52:55]
    v_mfma_f32_16x16x32_bf16 v[52:55], v[44:47], v[20:23], v[52:55]
    v_mfma_f32_16x16x32_bf16 v[68:71], v[188:191], v[8:11], v[68:71]
    ds_read_b128 v[8:11], v19 offset:30720
    v_mfma_f32_16x16x32_bf16 v[68:71], v[124:127], v[20:23], v[68:71]
    v_mfma_f32_16x16x32_bf16 v[48:51], v[144:147], v[24:27], v[48:51]
    v_mfma_f32_16x16x32_bf16 v[48:51], v[148:151], v[28:31], v[48:51]
    v_mfma_f32_16x16x32_bf16 v[64:67], v[240:243], v[24:27], v[64:67]
    v_mfma_f32_16x16x32_bf16 v[64:67], v[244:247], v[28:31], v[64:67]
    v_mfma_f32_16x16x32_bf16 v[52:55], v[128:131], v[24:27], v[52:55]
    v_mfma_f32_16x16x32_bf16 v[52:55], v[132:135], v[28:31], v[52:55]
    v_mfma_f32_16x16x32_bf16 v[56:59], v[112:115], v[24:27], v[56:59]
    v_mfma_f32_16x16x32_bf16 v[56:59], v[116:119], v[28:31], v[56:59]
    s_barrier
    v_mfma_f32_16x16x32_bf16 v[60:63], v[96:99], v[24:27], v[60:63]
    v_mfma_f32_16x16x32_bf16 v[60:63], v[100:103], v[28:31], v[60:63]
    v_mfma_f32_16x16x32_bf16 v[40:43], v[80:83], v[24:27], 0
    v_mfma_f32_16x16x32_bf16 v[40:43], v[84:87], v[28:31], v[40:43]
    v_mfma_f32_16x16x32_bf16 v[68:71], v[208:211], v[24:27], v[68:71]
    v_mfma_f32_16x16x32_bf16 v[68:71], v[212:215], v[28:31], v[68:71]
    v_mfma_f32_16x16x32_bf16 v[72:75], v[176:179], v[24:27], v[72:75]
    v_mfma_f32_16x16x32_bf16 v[72:75], v[180:183], v[28:31], v[72:75]
    ds_read_b128 v[24:27], v4 offset:46080
    s_waitcnt lgkmcnt(2)
    v_mfma_f32_16x16x32_bf16 v[48:51], v[152:155], v[32:35], v[48:51]
    ds_read_b128 v[28:31], v5 offset:46080
    s_waitcnt lgkmcnt(2)
    v_mfma_f32_16x16x32_bf16 v[48:51], v[204:207], v[8:11], v[48:51]
    s_nop 1
    v_mfma_f32_16x16x32_bf16 v[64:67], v[248:251], v[32:35], v[64:67]
    s_nop 1
    v_mfma_f32_16x16x32_bf16 v[64:67], v[252:255], v[36:39], v[64:67]
    s_nop 0
    v_mfma_f32_16x16x32_bf16 v[52:55], v[136:139], v[32:35], v[52:55]
    v_cvt_pk_bf16_f32 v16, v48, v49
    v_mfma_f32_16x16x32_bf16 v[52:55], v[140:143], v[8:11], v[52:55]
    v_cvt_pk_bf16_f32 v17, v50, v51
    v_mfma_f32_16x16x32_bf16 v[56:59], v[120:123], v[32:35], v[56:59]
    ds_write_b32 v12, v16 offset:33152
    v_mfma_f32_16x16x32_bf16 v[60:63], v[104:107], v[32:35], v[60:63]
    ds_write_b32 v12, v17 offset:33156
    v_mfma_f32_16x16x32_bf16 v[40:43], v[88:91], v[32:35], v[40:43]
    v_cvt_pk_bf16_f32 v14, v64, v65
    v_mfma_f32_16x16x32_bf16 v[40:43], v[92:95], v[36:39], v[40:43]
    v_cvt_pk_bf16_f32 v15, v66, v67
    v_mfma_f32_16x16x32_bf16 v[68:71], v[216:219], v[32:35], v[68:71]
    ds_read_b128 v[36:39], v7 offset:46080
    v_mfma_f32_16x16x32_bf16 v[68:71], v[220:223], v[8:11], v[68:71]
    ds_write_b32 v13, v14 offset:29824
    v_mfma_f32_16x16x32_bf16 v[72:75], v[184:187], v[32:35], v[72:75]
    ds_write_b32 v13, v15 offset:29828
    s_waitcnt lgkmcnt(6)
    v_mfma_f32_16x16x32_bf16 v[52:55], v[144:147], v[24:27], v[52:55]
    ds_read_b128 v[32:35], v6 offset:46080
    s_waitcnt lgkmcnt(6)
    v_mfma_f32_16x16x32_bf16 v[52:55], v[148:151], v[28:31], v[52:55]
    v_mfma_f32_16x16x32_bf16 v[68:71], v[224:227], v[24:27], v[68:71]
    v_mfma_f32_16x16x32_bf16 v[68:71], v[228:231], v[28:31], v[68:71]
    v_mfma_f32_16x16x32_bf16 v[56:59], v[128:131], v[24:27], v[56:59]
    v_mfma_f32_16x16x32_bf16 v[56:59], v[132:135], v[28:31], v[56:59]
    s_waitcnt lgkmcnt(1)
    s_barrier
    v_mfma_f32_16x16x32_bf16 v[60:63], v[112:115], v[24:27], v[60:63]
    v_mfma_f32_16x16x32_bf16 v[60:63], v[116:119], v[28:31], v[60:63]
    v_mfma_f32_16x16x32_bf16 v[40:43], v[96:99], v[24:27], v[40:43]
    v_mfma_f32_16x16x32_bf16 v[40:43], v[100:103], v[28:31], v[40:43]
    v_mfma_f32_16x16x32_bf16 v[48:51], v[80:83], v[24:27], 0
    v_mfma_f32_16x16x32_bf16 v[48:51], v[84:87], v[28:31], v[48:51]
    v_mfma_f32_16x16x32_bf16 v[72:75], v[192:195], v[24:27], v[72:75]
    v_mfma_f32_16x16x32_bf16 v[72:75], v[196:199], v[28:31], v[72:75]
    v_mfma_f32_16x16x32_bf16 v[64:67], v[160:163], v[24:27], 0
    v_mfma_f32_16x16x32_bf16 v[64:67], v[164:167], v[28:31], v[64:67]
    ds_read_b128 v[24:27], v4 offset:49920
    s_waitcnt lgkmcnt(1)
    v_mfma_f32_16x16x32_bf16 v[52:55], v[152:155], v[32:35], v[52:55]
    ds_read_b128 v[28:31], v5 offset:49920
    v_mfma_f32_16x16x32_bf16 v[52:55], v[156:159], v[36:39], v[52:55]
    ds_read_b128 v[8:11], v2 offset:38400
    v_mfma_f32_16x16x32_bf16 v[68:71], v[232:235], v[32:35], v[68:71]
    ds_read_b128 v[20:23], v3 offset:38400
    v_mfma_f32_16x16x32_bf16 v[68:71], v[236:239], v[36:39], v[68:71]
    s_nop 1
    v_mfma_f32_16x16x32_bf16 v[56:59], v[136:139], v[32:35], v[56:59]
    ds_read_b128 v[36:39], v7 offset:49920
    v_mfma_f32_16x16x32_bf16 v[60:63], v[120:123], v[32:35], v[60:63]
    v_cvt_pk_bf16_f32 v16, v52, v53
    v_mfma_f32_16x16x32_bf16 v[40:43], v[104:107], v[32:35], v[40:43]
    v_cvt_pk_bf16_f32 v17, v54, v55
    v_mfma_f32_16x16x32_bf16 v[48:51], v[88:91], v[32:35], v[48:51]
    ds_write_b32 v12, v16 offset:46336
    v_mfma_f32_16x16x32_bf16 v[72:75], v[200:203], v[32:35], v[72:75]
    ds_write_b32 v12, v17 offset:46340
    v_mfma_f32_16x16x32_bf16 v[64:67], v[168:171], v[32:35], v[64:67]
    s_waitcnt lgkmcnt(4)
    v_mfma_f32_16x16x32_bf16 v[56:59], v[108:111], v[8:11], v[56:59]
    ds_read_b128 v[32:35], v6 offset:49920
    s_waitcnt lgkmcnt(4)
    v_mfma_f32_16x16x32_bf16 v[56:59], v[76:79], v[20:23], v[56:59]
    v_mfma_f32_16x16x32_bf16 v[60:63], v[172:175], v[8:11], v[60:63]
    v_mfma_f32_16x16x32_bf16 v[60:63], v[44:47], v[20:23], v[60:63]
    v_mfma_f32_16x16x32_bf16 v[72:75], v[188:191], v[8:11], v[72:75]
    ds_read_b128 v[8:11], v19 offset:38400
    v_mfma_f32_16x16x32_bf16 v[72:75], v[124:127], v[20:23], v[72:75]
    ds_read_b128 v[80:83], v4 offset:53760
    v_mfma_f32_16x16x32_bf16 v[68:71], v[240:243], v[24:27], v[68:71]
    ds_read_b128 v[84:87], v5 offset:53760
    v_mfma_f32_16x16x32_bf16 v[68:71], v[244:247], v[28:31], v[68:71]
    ds_read_b128 v[88:91], v6 offset:53760
    s_waitcnt lgkmcnt(4)
    v_mfma_f32_16x16x32_bf16 v[68:71], v[248:251], v[32:35], v[68:71]
    ds_read_b128 v[92:95], v7 offset:53760
    v_mfma_f32_16x16x32_bf16 v[68:71], v[252:255], v[36:39], v[68:71]
    ds_read_b128 v[20:23], v3 offset:46080
    v_mfma_f32_16x16x32_bf16 v[56:59], v[144:147], v[24:27], v[56:59]
    ds_read_b128 v[160:163], v4 offset:57600
    v_mfma_f32_16x16x32_bf16 v[56:59], v[148:151], v[28:31], v[56:59]
    ds_read_b128 v[164:167], v5 offset:57600
    v_mfma_f32_16x16x32_bf16 v[56:59], v[152:155], v[32:35], v[56:59]
    ds_read_b128 v[168:171], v6 offset:57600
    s_waitcnt lgkmcnt(8)
    v_mfma_f32_16x16x32_bf16 v[56:59], v[204:207], v[8:11], v[56:59]
    ds_read_b128 v[36:39], v7 offset:57600
    v_mfma_f32_16x16x32_bf16 v[60:63], v[140:143], v[8:11], v[60:63]
    v_cvt_pk_bf16_f32 v14, v68, v69
    v_mfma_f32_16x16x32_bf16 v[60:63], v[128:131], v[24:27], v[60:63]
    v_cvt_pk_bf16_f32 v15, v70, v71
    v_mfma_f32_16x16x32_bf16 v[60:63], v[132:135], v[28:31], v[60:63]
    ds_write_b32 v13, v14 offset:46336
    v_mfma_f32_16x16x32_bf16 v[60:63], v[136:139], v[32:35], v[60:63]
    ds_write_b32 v13, v15 offset:46340
    v_mfma_f32_16x16x32_bf16 v[72:75], v[220:223], v[8:11], v[72:75]
    v_cvt_pk_bf16_f32 v16, v56, v57
    v_mfma_f32_16x16x32_bf16 v[72:75], v[208:211], v[24:27], v[72:75]
    v_cvt_pk_bf16_f32 v17, v58, v59
    v_mfma_f32_16x16x32_bf16 v[72:75], v[212:215], v[28:31], v[72:75]
    ds_write_b32 v12, v16 offset:49664
    v_mfma_f32_16x16x32_bf16 v[72:75], v[216:219], v[32:35], v[72:75]
    ds_write_b32 v12, v17 offset:49668
    v_mfma_f32_16x16x32_bf16 v[40:43], v[112:115], v[24:27], v[40:43]
    v_mfma_f32_16x16x32_bf16 v[40:43], v[116:119], v[28:31], v[40:43]
    v_mfma_f32_16x16x32_bf16 v[40:43], v[120:123], v[32:35], v[40:43]
    s_waitcnt lgkmcnt(12)
    v_mfma_f32_16x16x32_bf16 v[40:43], v[128:131], v[80:83], v[40:43]
    s_waitcnt lgkmcnt(11)
    v_mfma_f32_16x16x32_bf16 v[40:43], v[132:135], v[84:87], v[40:43]
    s_waitcnt lgkmcnt(0)
    s_barrier
    v_mfma_f32_16x16x32_bf16 v[40:43], v[136:139], v[88:91], v[40:43]
    ds_read_b128 v[8:11], v2 offset:46080
    v_mfma_f32_16x16x32_bf16 v[60:63], v[144:147], v[80:83], v[60:63]
    v_mfma_f32_16x16x32_bf16 v[60:63], v[148:151], v[84:87], v[60:63]
    v_mfma_f32_16x16x32_bf16 v[60:63], v[152:155], v[88:91], v[60:63]
    v_mfma_f32_16x16x32_bf16 v[60:63], v[156:159], v[92:95], v[60:63]
    s_nop 1
    s_waitcnt lgkmcnt(0)
    v_mfma_f32_16x16x32_bf16 v[40:43], v[108:111], v[8:11], v[40:43]
    s_nop 1
    v_mfma_f32_16x16x32_bf16 v[40:43], v[76:79], v[20:23], v[40:43]
    v_mfma_f32_16x16x32_bf16 v[48:51], v[172:175], v[8:11], v[48:51]
    v_cvt_pk_bf16_f32 v14, v60, v61
    v_mfma_f32_16x16x32_bf16 v[48:51], v[44:47], v[20:23], v[48:51]
    v_cvt_pk_bf16_f32 v15, v62, v63
    v_mfma_f32_16x16x32_bf16 v[64:67], v[188:191], v[8:11], v[64:67]
    ds_read_b128 v[8:11], v19 offset:46080
    v_mfma_f32_16x16x32_bf16 v[64:67], v[124:127], v[20:23], v[64:67]
    ds_write_b32 v12, v14 offset:52992
    v_mfma_f32_16x16x32_bf16 v[72:75], v[224:227], v[80:83], v[72:75]
    ds_write_b32 v12, v15 offset:52996
    v_mfma_f32_16x16x32_bf16 v[72:75], v[228:231], v[84:87], v[72:75]
    v_mfma_f32_16x16x32_bf16 v[72:75], v[232:235], v[88:91], v[72:75]
    v_mfma_f32_16x16x32_bf16 v[72:75], v[236:239], v[92:95], v[72:75]
    v_mfma_f32_16x16x32_bf16 v[72:75], v[240:243], v[160:163], v[72:75]
    ds_read_b128 v[240:243], v4 offset:61440
    v_mfma_f32_16x16x32_bf16 v[72:75], v[244:247], v[164:167], v[72:75]
    ds_read_b128 v[244:247], v5 offset:61440
    v_mfma_f32_16x16x32_bf16 v[72:75], v[248:251], v[168:171], v[72:75]
    ds_read_b128 v[248:251], v6 offset:61440
    v_mfma_f32_16x16x32_bf16 v[72:75], v[252:255], v[36:39], v[72:75]
    ds_read_b128 v[252:255], v7 offset:61440
    v_mfma_f32_16x16x32_bf16 v[40:43], v[144:147], v[160:163], v[40:43]
    s_nop 1
    v_mfma_f32_16x16x32_bf16 v[40:43], v[148:151], v[164:167], v[40:43]
    s_nop 1
    v_mfma_f32_16x16x32_bf16 v[40:43], v[152:155], v[168:171], v[40:43]
    v_cvt_pk_bf16_f32 v16, v72, v73
    s_waitcnt lgkmcnt(6)
    v_mfma_f32_16x16x32_bf16 v[40:43], v[204:207], v[8:11], v[40:43]
    v_cvt_pk_bf16_f32 v17, v74, v75
    v_mfma_f32_16x16x32_bf16 v[64:67], v[220:223], v[8:11], v[64:67]
    ds_write_b32 v13, v16 offset:52992
    v_mfma_f32_16x16x32_bf16 v[64:67], v[176:179], v[24:27], v[64:67]
    ds_write_b32 v13, v17 offset:52996
    v_mfma_f32_16x16x32_bf16 v[64:67], v[180:183], v[28:31], v[64:67]
    s_nop 0
    v_mfma_f32_16x16x32_bf16 v[64:67], v[184:187], v[32:35], v[64:67]
    v_cvt_pk_bf16_f32 v14, v40, v41
    v_mfma_f32_16x16x32_bf16 v[64:67], v[192:195], v[80:83], v[64:67]
    v_cvt_pk_bf16_f32 v15, v42, v43
    v_mfma_f32_16x16x32_bf16 v[64:67], v[196:199], v[84:87], v[64:67]
    ds_write_b32 v12, v14 offset:56320
    v_mfma_f32_16x16x32_bf16 v[64:67], v[200:203], v[88:91], v[64:67]
    ds_write_b32 v12, v15 offset:56324
    v_mfma_f32_16x16x32_bf16 v[48:51], v[140:143], v[8:11], v[48:51]
    v_mfma_f32_16x16x32_bf16 v[48:51], v[96:99], v[24:27], v[48:51]
    v_mfma_f32_16x16x32_bf16 v[48:51], v[100:103], v[28:31], v[48:51]
    v_mfma_f32_16x16x32_bf16 v[48:51], v[104:107], v[32:35], v[48:51]
    v_mfma_f32_16x16x32_bf16 v[48:51], v[112:115], v[80:83], v[48:51]
    s_waitcnt lgkmcnt(0)
    s_barrier
    v_mfma_f32_16x16x32_bf16 v[48:51], v[116:119], v[84:87], v[48:51]
    v_mfma_f32_16x16x32_bf16 v[48:51], v[120:123], v[88:91], v[48:51]
    v_mfma_f32_16x16x32_bf16 v[48:51], v[128:131], v[160:163], v[48:51]
    v_mfma_f32_16x16x32_bf16 v[48:51], v[132:135], v[164:167], v[48:51]
    v_mfma_f32_16x16x32_bf16 v[48:51], v[136:139], v[168:171], v[48:51]
    v_mfma_f32_16x16x32_bf16 v[48:51], v[144:147], v[240:243], v[48:51]
    v_mfma_f32_16x16x32_bf16 v[48:51], v[148:151], v[244:247], v[48:51]
    v_mfma_f32_16x16x32_bf16 v[48:51], v[152:155], v[248:251], v[48:51]
    v_mfma_f32_16x16x32_bf16 v[48:51], v[156:159], v[252:255], v[48:51]
    s_nop 1
    v_mfma_f32_16x16x32_bf16 v[64:67], v[208:211], v[160:163], v[64:67]
    s_nop 1
    v_mfma_f32_16x16x32_bf16 v[64:67], v[212:215], v[164:167], v[64:67]
    s_nop 0
    v_mfma_f32_16x16x32_bf16 v[64:67], v[216:219], v[168:171], v[64:67]
    v_cvt_pk_bf16_f32 v16, v48, v49
    v_mfma_f32_16x16x32_bf16 v[64:67], v[224:227], v[240:243], v[64:67]
    v_cvt_pk_bf16_f32 v17, v50, v51
    v_mfma_f32_16x16x32_bf16 v[64:67], v[228:231], v[244:247], v[64:67]
    ds_write_b32 v12, v16 offset:59648
    v_mfma_f32_16x16x32_bf16 v[64:67], v[232:235], v[248:251], v[64:67]
    ds_write_b32 v12, v17 offset:59652
    v_mfma_f32_16x16x32_bf16 v[64:67], v[236:239], v[252:255], v[64:67]
    s_nop 1
    s_nop 5
    v_cvt_pk_bf16_f32 v14, v64, v65
    v_cvt_pk_bf16_f32 v15, v66, v67
    ds_write_b64 v13, v[14:15] offset:59648
    s_waitcnt lgkmcnt(0)
    s_barrier
    s_endpgm
L_rolestore:
L_padret:
    s_mov_b64 exec, -1
    s_and_b32 s24, s29, 1
    s_cmpk_lt_u32 s29, 224
    s_cselect_b32 s34, s24, 0
    s_mul_i32 s26, s29, 2341
    s_lshr_b32 s26, s26, 16
    s_mul_i32 s3, s26, 28
    s_sub_u32 s25, s29, s3
    s_lshr_b32 s25, s25, 1
    s_mul_i32 s33, s26, 25
    s_cmp_lg_u32 s24, 0
    s_cselect_b32 s3, 12, 11
    s_cselect_b32 s28, 1, -1
    s_add_u32 s33, s33, s3
    s_mul_i32 s33, s33, 14
    s_add_u32 s33, s33, s25
    s_mulk_i32 s33, 3072
    s_mul_i32 s28, s28, 43008
    s_sub_u32 s3, s27, 1
    s_lshl_b32 s3, s3, 6
    v_add_u32 v2, s3, v1
    v_lshlrev_b32 v5, 4, v2
    v_mul_u32_u24 v3, 171, v2
    v_lshrrev_b32 v3, 11, v3
    v_add_u32 v2, v2, v3
    v_lshlrev_b32 v6, 4, v2
    v_add_u32 v6, 70272, v6
    s_mov_b32 s23, 0x20000
    s_mov_b32 s22, 9633792
    s_waitcnt lgkmcnt(0)
    s_mov_b32 s20, s8
    s_and_b32 s21, s9, 0xffff
    s_barrier
    s_barrier
    s_barrier
    s_barrier
    s_barrier
    s_barrier
    s_barrier
    s_barrier
    s_barrier
    ds_read_b128 v[8:11], v6 offset:0
    ds_read_b128 v[12:15], v6 offset:3328
    ds_read_b128 v[16:19], v6 offset:6656
    ds_read_b128 v[20:23], v6 offset:9984
    s_waitcnt lgkmcnt(3)
    buffer_store_dwordx4 v[8:11], v5, s[20:23], s33 offen sc0 sc1
    s_add_u32 s33, s33, s28
    s_waitcnt lgkmcnt(2)
    buffer_store_dwordx4 v[12:15], v5, s[20:23], s33 offen sc0 sc1
    s_add_u32 s33, s33, s28
    s_waitcnt lgkmcnt(1)
    buffer_store_dwordx4 v[16:19], v5, s[20:23], s33 offen sc0 sc1
    s_add_u32 s33, s33, s28
    s_waitcnt lgkmcnt(0)
    buffer_store_dwordx4 v[20:23], v5, s[20:23], s33 offen sc0 sc1
    s_add_u32 s33, s33, s28
    s_barrier
    ds_read_b128 v[24:27], v6 offset:23168
    ds_read_b128 v[28:31], v6 offset:26496
    s_waitcnt lgkmcnt(1)
    buffer_store_dwordx4 v[24:27], v5, s[20:23], s33 offen sc0 sc1
    s_add_u32 s33, s33, s28
    s_waitcnt lgkmcnt(0)
    buffer_store_dwordx4 v[28:31], v5, s[20:23], s33 offen sc0 sc1
    s_add_u32 s33, s33, s28
    s_barrier
    ds_read_b128 v[8:11], v6 offset:29824
    ds_read_b128 v[12:15], v6 offset:33152
    s_waitcnt lgkmcnt(1)
    buffer_store_dwordx4 v[8:11], v5, s[20:23], s33 offen sc0 sc1
    s_add_u32 s33, s33, s28
    s_waitcnt lgkmcnt(0)
    buffer_store_dwordx4 v[12:15], v5, s[20:23], s33 offen sc0 sc1
    s_add_u32 s33, s33, s28
    s_barrier
    ds_read_b128 v[24:27], v6 offset:46336
    ds_read_b128 v[28:31], v6 offset:49664
    s_waitcnt lgkmcnt(1)
    buffer_store_dwordx4 v[24:27], v5, s[20:23], s33 offen sc0 sc1
    s_add_u32 s33, s33, s28
    s_waitcnt lgkmcnt(0)
    buffer_store_dwordx4 v[28:31], v5, s[20:23], s33 offen sc0 sc1
    s_add_u32 s33, s33, s28
    s_barrier
    ds_read_b128 v[8:11], v6 offset:52992
    ds_read_b128 v[12:15], v6 offset:56320
    s_waitcnt lgkmcnt(1)
    buffer_store_dwordx4 v[8:11], v5, s[20:23], s33 offen sc0 sc1
    s_add_u32 s33, s33, s28
    s_waitcnt lgkmcnt(0)
    s_cmp_eq_u32 s34, 0
    s_cbranch_scc1 L_s12
    buffer_store_dwordx4 v[12:15], v5, s[20:23], s33 offen sc0 sc1
    s_add_u32 s33, s33, s28
    v_add_u32 v6, 3328, v6
L_s12:
    s_barrier
    ds_read_b128 v[48:51], v6 offset:56320
    s_waitcnt lgkmcnt(0)
    buffer_store_dwordx4 v[48:51], v5, s[20:23], s33 offen sc0 sc1
L_fins:
    s_endpgm
.p2align 6
L_go12:
    s_cbranch_execz L_padret
    s_barrier
    ds_read_b128 v[192:195], v4 offset:0
    ds_read_b128 v[196:199], v5 offset:0
    ds_read_b128 v[200:203], v6 offset:0
    ds_read_b128 v[204:207], v7 offset:0
    ds_read_b128 v[208:211], v4 offset:3840
    ds_read_b128 v[212:215], v5 offset:3840
    ds_read_b128 v[216:219], v6 offset:3840
    ds_read_b128 v[220:223], v7 offset:3840
    ds_read_b128 v[144:147], v4 offset:7680
    ds_read_b128 v[148:151], v5 offset:7680
    ds_read_b128 v[152:155], v6 offset:7680
    ds_read_b128 v[156:159], v7 offset:7680
    ds_read_b128 v[224:227], v4 offset:11520
    ds_read_b128 v[228:231], v5 offset:11520
    ds_read_b128 v[232:235], v6 offset:11520
    ds_read_b128 v[236:239], v7 offset:11520
    ds_read_b128 v[240:243], v4 offset:15360
    ds_read_b128 v[244:247], v5 offset:15360
    ds_read_b128 v[248:251], v6 offset:15360
    ds_read_b128 v[252:255], v7 offset:15360
    ds_read_b128 v[24:27], v4 offset:19200
    ds_read_b128 v[28:31], v5 offset:19200
    ds_read_b128 v[32:35], v6 offset:19200
    ds_read_b128 v[36:39], v7 offset:19200
    s_barrier
    ds_read_b64_tr_b16 v[80:81], v8 offset:0
    ds_read_b64_tr_b16 v[82:83], v9 offset:0
    ds_read_b64_tr_b16 v[84:85], v8 offset:384
    ds_read_b64_tr_b16 v[86:87], v9 offset:384
    ds_read_b64_tr_b16 v[88:89], v8 offset:768
    ds_read_b64_tr_b16 v[90:91], v9 offset:768
    ds_read_b64_tr_b16 v[92:93], v10 offset:0
    ds_read_b64_tr_b16 v[94:95], v10 offset:128
    s_waitcnt lgkmcnt(6)
    v_mfma_f32_16x16x32_bf16 v[40:43], v[80:83], v[192:195], 0
    ds_read_b64_tr_b16 v[160:161], v11 offset:0
    v_mfma_f32_16x16x32_bf16 v[44:47], v[80:83], v[208:211], 0
    ds_read_b64_tr_b16 v[162:163], v20 offset:0
    v_mfma_f32_16x16x32_bf16 v[48:51], v[80:83], v[144:147], 0
    ds_read_b64_tr_b16 v[164:165], v11 offset:384
    v_mfma_f32_16x16x32_bf16 v[52:55], v[80:83], v[224:227], 0
    ds_read_b64_tr_b16 v[166:167], v20 offset:384
    v_mfma_f32_16x16x32_bf16 v[56:59], v[80:83], v[240:243], 0
    ds_read_b64_tr_b16 v[168:169], v11 offset:768
    s_waitcnt lgkmcnt(9)
    v_mfma_f32_16x16x32_bf16 v[40:43], v[84:87], v[196:199], v[40:43]
    ds_read_b64_tr_b16 v[170:171], v20 offset:768
    v_mfma_f32_16x16x32_bf16 v[44:47], v[84:87], v[212:215], v[44:47]
    ds_read_b64_tr_b16 v[172:173], v21 offset:0
    v_mfma_f32_16x16x32_bf16 v[48:51], v[84:87], v[148:151], v[48:51]
    ds_read_b64_tr_b16 v[174:175], v21 offset:64
    v_mfma_f32_16x16x32_bf16 v[52:55], v[84:87], v[228:231], v[52:55]
    v_sub_u32 v11, v11, v18
    v_mfma_f32_16x16x32_bf16 v[56:59], v[84:87], v[244:247], v[56:59]
    v_sub_u32 v20, v20, v18
    s_waitcnt lgkmcnt(10)
    v_mfma_f32_16x16x32_bf16 v[40:43], v[88:91], v[200:203], v[40:43]
    v_sub_u32 v21, v21, v18
    v_mfma_f32_16x16x32_bf16 v[44:47], v[88:91], v[216:219], v[44:47]
    v_mfma_f32_16x16x32_bf16 v[48:51], v[88:91], v[152:155], v[48:51]
    v_mfma_f32_16x16x32_bf16 v[52:55], v[88:91], v[232:235], v[52:55]
    v_mfma_f32_16x16x32_bf16 v[56:59], v[88:91], v[248:251], v[56:59]
    s_waitcnt lgkmcnt(8)
    v_mfma_f32_16x16x32_bf16 v[40:43], v[92:95], v[204:207], v[40:43]
    v_mfma_f32_16x16x32_bf16 v[44:47], v[92:95], v[220:223], v[44:47]
    v_mfma_f32_16x16x32_bf16 v[48:51], v[92:95], v[156:159], v[48:51]
    v_mfma_f32_16x16x32_bf16 v[52:55], v[92:95], v[236:239], v[52:55]
    v_mfma_f32_16x16x32_bf16 v[56:59], v[92:95], v[252:255], v[56:59]
    s_waitcnt lgkmcnt(6)
    v_mfma_f32_16x16x32_bf16 v[64:67], v[160:163], v[192:195], 0
    s_waitcnt lgkmcnt(4)
    v_mfma_f32_16x16x32_bf16 v[64:67], v[164:167], v[196:199], v[64:67]
    ds_read_b32 v23, v22 offset:28
    v_mfma_f32_16x16x32_bf16 v[68:71], v[160:163], v[144:147], 0
    v_mfma_f32_16x16x32_bf16 v[68:71], v[164:167], v[148:151], v[68:71]
    s_waitcnt lgkmcnt(3)
    v_mfma_f32_16x16x32_bf16 v[64:67], v[168:171], v[200:203], v[64:67]
    s_waitcnt lgkmcnt(1)
    v_mfma_f32_16x16x32_bf16 v[64:67], v[172:175], v[204:207], v[64:67]
    s_waitcnt lgkmcnt(0)
    v_cmp_eq_u32 vcc, 0, v23
    v_mfma_f32_16x16x32_bf16 v[68:71], v[168:171], v[152:155], v[68:71]
    v_mfma_f32_16x16x32_bf16 v[68:71], v[172:175], v[156:159], v[68:71]
    s_cbranch_vccz L_spin1_12
L_back1_12:
    v_mfma_f32_16x16x32_bf16 v[72:75], v[160:163], v[240:243], 0
    ds_read_b64_tr_b16 v[96:97], v8 offset:23168
    v_mfma_f32_16x16x32_bf16 v[72:75], v[164:167], v[244:247], v[72:75]
    ds_read_b64_tr_b16 v[98:99], v9 offset:23168
    v_mfma_f32_16x16x32_bf16 v[60:63], v[80:83], v[24:27], 0
    ds_read_b64_tr_b16 v[100:101], v8 offset:23552
    v_mfma_f32_16x16x32_bf16 v[60:63], v[84:87], v[28:31], v[60:63]
    ds_read_b64_tr_b16 v[102:103], v9 offset:23552
    v_mfma_f32_16x16x32_bf16 v[72:75], v[168:171], v[248:251], v[72:75]
    ds_read_b64_tr_b16 v[104:105], v8 offset:23936
    v_mfma_f32_16x16x32_bf16 v[72:75], v[172:175], v[252:255], v[72:75]
    ds_read_b64_tr_b16 v[106:107], v9 offset:23936
    v_mfma_f32_16x16x32_bf16 v[60:63], v[88:91], v[32:35], v[60:63]
    ds_read_b64_tr_b16 v[108:109], v10 offset:23168
    v_mfma_f32_16x16x32_bf16 v[60:63], v[92:95], v[36:39], v[60:63]
    ds_read_b64_tr_b16 v[110:111], v10 offset:23296
    s_waitcnt lgkmcnt(6)
    v_mfma_f32_16x16x32_bf16 v[40:43], v[96:99], v[208:211], v[40:43]
    ds_read_b64_tr_b16 v[176:177], v11 offset:23168
    s_waitcnt lgkmcnt(5)
    v_mfma_f32_16x16x32_bf16 v[40:43], v[100:103], v[212:215], v[40:43]
    ds_read_b64_tr_b16 v[178:179], v20 offset:23168
    v_mfma_f32_16x16x32_bf16 v[44:47], v[96:99], v[144:147], v[44:47]
    ds_read_b64_tr_b16 v[180:181], v11 offset:23552
    v_mfma_f32_16x16x32_bf16 v[44:47], v[100:103], v[148:151], v[44:47]
    ds_read_b64_tr_b16 v[182:183], v20 offset:23552
    v_mfma_f32_16x16x32_bf16 v[48:51], v[96:99], v[224:227], v[48:51]
    ds_read_b64_tr_b16 v[184:185], v11 offset:23936
    v_mfma_f32_16x16x32_bf16 v[48:51], v[100:103], v[228:231], v[48:51]
    ds_read_b64_tr_b16 v[186:187], v20 offset:23936
    v_mfma_f32_16x16x32_bf16 v[52:55], v[96:99], v[240:243], v[52:55]
    ds_read_b64_tr_b16 v[188:189], v21 offset:23168
    v_mfma_f32_16x16x32_bf16 v[52:55], v[100:103], v[244:247], v[52:55]
    ds_read_b64_tr_b16 v[190:191], v21 offset:23232
    s_waitcnt lgkmcnt(10)
    v_mfma_f32_16x16x32_bf16 v[40:43], v[104:107], v[216:219], v[40:43]
    s_waitcnt lgkmcnt(8)
    v_mfma_f32_16x16x32_bf16 v[40:43], v[108:111], v[220:223], v[40:43]
    ds_read_b32 v23, v22 offset:24
    v_mfma_f32_16x16x32_bf16 v[44:47], v[104:107], v[152:155], v[44:47]
    v_mfma_f32_16x16x32_bf16 v[44:47], v[108:111], v[156:159], v[44:47]
    v_mfma_f32_16x16x32_bf16 v[48:51], v[104:107], v[232:235], v[48:51]
    v_mfma_f32_16x16x32_bf16 v[48:51], v[108:111], v[236:239], v[48:51]
    s_waitcnt lgkmcnt(0)
    v_cmp_eq_u32 vcc, 0, v23
    v_mfma_f32_16x16x32_bf16 v[52:55], v[104:107], v[248:251], v[52:55]
    v_mfma_f32_16x16x32_bf16 v[52:55], v[108:111], v[252:255], v[52:55]
    s_cbranch_vccz L_spin2_12
L_back2_12:
    v_mfma_f32_16x16x32_bf16 v[64:67], v[176:179], v[208:211], v[64:67]
    ds_read_b64_tr_b16 v[112:113], v8 offset:46336
    v_mfma_f32_16x16x32_bf16 v[64:67], v[180:183], v[212:215], v[64:67]
    ds_read_b64_tr_b16 v[114:115], v9 offset:46336
    v_mfma_f32_16x16x32_bf16 v[68:71], v[176:179], v[224:227], v[68:71]
    ds_read_b64_tr_b16 v[116:117], v8 offset:46720
    v_mfma_f32_16x16x32_bf16 v[68:71], v[180:183], v[228:231], v[68:71]
    ds_read_b64_tr_b16 v[118:119], v9 offset:46720
    v_mfma_f32_16x16x32_bf16 v[72:75], v[176:179], v[24:27], v[72:75]
    ds_read_b64_tr_b16 v[120:121], v8 offset:47104
    v_mfma_f32_16x16x32_bf16 v[72:75], v[180:183], v[28:31], v[72:75]
    ds_read_b64_tr_b16 v[122:123], v9 offset:47104
    v_mfma_f32_16x16x32_bf16 v[56:59], v[96:99], v[24:27], v[56:59]
    ds_read_b64_tr_b16 v[124:125], v10 offset:46336
    v_mfma_f32_16x16x32_bf16 v[56:59], v[100:103], v[28:31], v[56:59]
    ds_read_b64_tr_b16 v[126:127], v10 offset:46464
    v_mfma_f32_16x16x32_bf16 v[64:67], v[184:187], v[216:219], v[64:67]
    v_add_u32 v8, 69504, v8
    v_mfma_f32_16x16x32_bf16 v[64:67], v[188:191], v[220:223], v[64:67]
    v_add_u32 v9, 69504, v9
    v_mfma_f32_16x16x32_bf16 v[68:71], v[184:187], v[232:235], v[68:71]
    v_add_u32 v10, 69504, v10
    v_mfma_f32_16x16x32_bf16 v[68:71], v[188:191], v[236:239], v[68:71]
    ds_read_b64_tr_b16 v[192:193], v11 offset:46336
    v_mfma_f32_16x16x32_bf16 v[72:75], v[184:187], v[32:35], v[72:75]
    ds_read_b64_tr_b16 v[194:195], v20 offset:46336
    v_mfma_f32_16x16x32_bf16 v[72:75], v[188:191], v[36:39], v[72:75]
    ds_read_b64_tr_b16 v[196:197], v11 offset:46720
    v_mfma_f32_16x16x32_bf16 v[56:59], v[104:107], v[32:35], v[56:59]
    ds_read_b64_tr_b16 v[198:199], v20 offset:46720
    v_mfma_f32_16x16x32_bf16 v[56:59], v[108:111], v[36:39], v[56:59]
    ds_read_b64_tr_b16 v[200:201], v11 offset:47104
    s_waitcnt lgkmcnt(11)
    v_mfma_f32_16x16x32_bf16 v[40:43], v[112:115], v[144:147], v[40:43]
    ds_read_b64_tr_b16 v[202:203], v20 offset:47104
    s_waitcnt lgkmcnt(10)
    v_mfma_f32_16x16x32_bf16 v[40:43], v[116:119], v[148:151], v[40:43]
    ds_read_b32 v23, v22 offset:20
    v_mfma_f32_16x16x32_bf16 v[44:47], v[112:115], v[224:227], v[44:47]
    ds_read_b64_tr_b16 v[204:205], v21 offset:46336
    v_mfma_f32_16x16x32_bf16 v[44:47], v[116:119], v[228:231], v[44:47]
    ds_read_b64_tr_b16 v[206:207], v21 offset:46400
    s_waitcnt lgkmcnt(11)
    v_mfma_f32_16x16x32_bf16 v[40:43], v[120:123], v[152:155], v[40:43]
    v_add_u32 v11, 69504, v11
    s_waitcnt lgkmcnt(9)
    v_mfma_f32_16x16x32_bf16 v[40:43], v[124:127], v[156:159], v[40:43]
    v_add_u32 v20, 69504, v20
    v_mfma_f32_16x16x32_bf16 v[44:47], v[120:123], v[232:235], v[44:47]
    v_add_u32 v21, 69504, v21
    v_mfma_f32_16x16x32_bf16 v[44:47], v[124:127], v[236:239], v[44:47]
    s_waitcnt lgkmcnt(2)
    v_cmp_eq_u32 vcc, 0, v23
    v_mfma_f32_16x16x32_bf16 v[64:67], v[192:195], v[144:147], v[64:67]
    s_cbranch_vccz L_spin3_12
L_back3_12:
    v_mfma_f32_16x16x32_bf16 v[64:67], v[196:199], v[148:151], v[64:67]
    ds_read_b64_tr_b16 v[128:129], v8 offset:0
    v_mfma_f32_16x16x32_bf16 v[68:71], v[192:195], v[240:243], v[68:71]
    ds_read_b64_tr_b16 v[130:131], v9 offset:0
    v_mfma_f32_16x16x32_bf16 v[68:71], v[196:199], v[244:247], v[68:71]
    ds_read_b64_tr_b16 v[132:133], v8 offset:384
    v_mfma_f32_16x16x32_bf16 v[48:51], v[112:115], v[240:243], v[48:51]
    ds_read_b64_tr_b16 v[134:135], v9 offset:384
    v_mfma_f32_16x16x32_bf16 v[48:51], v[116:119], v[244:247], v[48:51]
    ds_read_b64_tr_b16 v[136:137], v8 offset:768
    v_mfma_f32_16x16x32_bf16 v[52:55], v[112:115], v[24:27], v[52:55]
    ds_read_b64_tr_b16 v[138:139], v9 offset:768
    v_mfma_f32_16x16x32_bf16 v[52:55], v[116:119], v[28:31], v[52:55]
    ds_read_b64_tr_b16 v[140:141], v10 offset:0
    v_mfma_f32_16x16x32_bf16 v[64:67], v[200:203], v[152:155], v[64:67]
    ds_read_b64_tr_b16 v[142:143], v10 offset:128
    s_waitcnt lgkmcnt(8)
    v_mfma_f32_16x16x32_bf16 v[64:67], v[204:207], v[156:159], v[64:67]
    ds_read_b64_tr_b16 v[208:209], v11 offset:0
    v_mfma_f32_16x16x32_bf16 v[68:71], v[200:203], v[248:251], v[68:71]
    ds_read_b64_tr_b16 v[210:211], v20 offset:0
    v_mfma_f32_16x16x32_bf16 v[68:71], v[204:207], v[252:255], v[68:71]
    ds_read_b64_tr_b16 v[212:213], v11 offset:384
    v_mfma_f32_16x16x32_bf16 v[48:51], v[120:123], v[248:251], v[48:51]
    ds_read_b64_tr_b16 v[214:215], v20 offset:384
    v_mfma_f32_16x16x32_bf16 v[48:51], v[124:127], v[252:255], v[48:51]
    ds_read_b64_tr_b16 v[216:217], v11 offset:768
L_padc:
    s_cbranch_execz L_padret
    v_mfma_f32_16x16x32_bf16 v[52:55], v[120:123], v[32:35], v[52:55]
    ds_read_b64_tr_b16 v[218:219], v20 offset:768
    v_mfma_f32_16x16x32_bf16 v[52:55], v[124:127], v[36:39], v[52:55]
    ds_read_b64_tr_b16 v[220:221], v21 offset:0
    s_waitcnt lgkmcnt(13)
    v_mfma_f32_16x16x32_bf16 v[40:43], v[128:131], v[224:227], v[40:43]
    ds_read_b64_tr_b16 v[222:223], v21 offset:64
    s_waitcnt lgkmcnt(12)
    v_mfma_f32_16x16x32_bf16 v[40:43], v[132:135], v[228:231], v[40:43]
    s_waitcnt lgkmcnt(10)
    v_mfma_f32_16x16x32_bf16 v[40:43], v[136:139], v[232:235], v[40:43]
    s_waitcnt lgkmcnt(8)
    v_mfma_f32_16x16x32_bf16 v[40:43], v[140:143], v[236:239], v[40:43]
    s_barrier
    s_waitcnt lgkmcnt(6)
    v_mfma_f32_16x16x32_bf16 v[64:67], v[208:211], v[224:227], v[64:67]
    ds_read_b64_tr_b16 v[144:145], v8 offset:23168
    s_waitcnt lgkmcnt(5)
    v_mfma_f32_16x16x32_bf16 v[64:67], v[212:215], v[228:231], v[64:67]
    ds_read_b64_tr_b16 v[146:147], v9 offset:23168
    v_mfma_f32_16x16x32_bf16 v[44:47], v[128:131], v[240:243], v[44:47]
    ds_read_b64_tr_b16 v[148:149], v8 offset:23552
    v_mfma_f32_16x16x32_bf16 v[44:47], v[132:135], v[244:247], v[44:47]
    ds_read_b64_tr_b16 v[150:151], v9 offset:23552
    s_waitcnt lgkmcnt(6)
    v_mfma_f32_16x16x32_bf16 v[64:67], v[216:219], v[232:235], v[64:67]
    ds_read_b64_tr_b16 v[152:153], v8 offset:23936
    s_waitcnt lgkmcnt(5)
    v_mfma_f32_16x16x32_bf16 v[64:67], v[220:223], v[236:239], v[64:67]
    ds_read_b64_tr_b16 v[154:155], v9 offset:23936
    v_mfma_f32_16x16x32_bf16 v[44:47], v[136:139], v[248:251], v[44:47]
    ds_read_b64_tr_b16 v[156:157], v10 offset:23168
    v_mfma_f32_16x16x32_bf16 v[44:47], v[140:143], v[252:255], v[44:47]
    ds_read_b64_tr_b16 v[158:159], v10 offset:23296
    v_mfma_f32_16x16x32_bf16 v[48:51], v[128:131], v[24:27], v[48:51]
    ds_read_b64_tr_b16 v[224:225], v11 offset:23168
    v_mfma_f32_16x16x32_bf16 v[48:51], v[132:135], v[28:31], v[48:51]
    ds_read_b64_tr_b16 v[226:227], v20 offset:23168
    s_waitcnt lgkmcnt(8)
    v_mfma_f32_16x16x32_bf16 v[40:43], v[144:147], v[240:243], v[40:43]
    ds_read_b64_tr_b16 v[228:229], v11 offset:23552
    s_waitcnt lgkmcnt(7)
    v_mfma_f32_16x16x32_bf16 v[40:43], v[148:151], v[244:247], v[40:43]
    ds_read_b64_tr_b16 v[230:231], v20 offset:23552
    v_mfma_f32_16x16x32_bf16 v[48:51], v[136:139], v[32:35], v[48:51]
    ds_read_b64_tr_b16 v[232:233], v11 offset:23936
    v_mfma_f32_16x16x32_bf16 v[48:51], v[140:143], v[36:39], v[48:51]
    ds_read_b64_tr_b16 v[234:235], v20 offset:23936
    s_waitcnt lgkmcnt(8)
    v_mfma_f32_16x16x32_bf16 v[40:43], v[152:155], v[248:251], v[40:43]
    ds_read_b64_tr_b16 v[236:237], v21 offset:23168
    s_waitcnt lgkmcnt(7)
    v_mfma_f32_16x16x32_bf16 v[40:43], v[156:159], v[252:255], v[40:43]
    ds_read_b64_tr_b16 v[238:239], v21 offset:23232
    s_waitcnt lgkmcnt(6)
    v_mfma_f32_16x16x32_bf16 v[64:67], v[224:227], v[240:243], v[64:67]
    ds_read_b64_tr_b16 v[240:241], v2 offset:46336
    s_waitcnt lgkmcnt(5)
    v_mfma_f32_16x16x32_bf16 v[64:67], v[228:231], v[244:247], v[64:67]
    ds_read_b64_tr_b16 v[242:243], v3 offset:46336
    v_mfma_f32_16x16x32_bf16 v[68:71], v[208:211], v[24:27], v[68:71]
    ds_read_b64_tr_b16 v[244:245], v2 offset:46720
    v_mfma_f32_16x16x32_bf16 v[68:71], v[212:215], v[28:31], v[68:71]
    ds_read_b64_tr_b16 v[246:247], v3 offset:46720
    s_waitcnt lgkmcnt(6)
    v_mfma_f32_16x16x32_bf16 v[64:67], v[232:235], v[248:251], v[64:67]
    ds_read_b64_tr_b16 v[248:249], v2 offset:47104
    s_waitcnt lgkmcnt(5)
    v_mfma_f32_16x16x32_bf16 v[64:67], v[236:239], v[252:255], v[64:67]
    ds_read_b64_tr_b16 v[250:251], v3 offset:47104
    v_mfma_f32_16x16x32_bf16 v[68:71], v[216:219], v[32:35], v[68:71]
    ds_read_b64_tr_b16 v[252:253], v19 offset:46336
    v_mfma_f32_16x16x32_bf16 v[68:71], v[220:223], v[36:39], v[68:71]
    ds_read_b64_tr_b16 v[254:255], v19 offset:46400
    v_mfma_f32_16x16x32_bf16 v[44:47], v[144:147], v[24:27], v[44:47]
    s_barrier
    v_mfma_f32_16x16x32_bf16 v[44:47], v[148:151], v[28:31], v[44:47]
    v_cvt_pk_bf16_f32 v8, v40, v41
    s_waitcnt lgkmcnt(6)
    v_mfma_f32_16x16x32_bf16 v[64:67], v[240:243], v[24:27], v[64:67]
    ds_read_b128 v[24:27], v4 offset:23040
    s_waitcnt lgkmcnt(5)
    v_mfma_f32_16x16x32_bf16 v[64:67], v[244:247], v[28:31], v[64:67]
    ds_read_b128 v[28:31], v5 offset:23040
    v_mfma_f32_16x16x32_bf16 v[44:47], v[152:155], v[32:35], v[44:47]
    v_cvt_pk_bf16_f32 v9, v42, v43
    v_mfma_f32_16x16x32_bf16 v[44:47], v[156:159], v[36:39], v[44:47]
    s_nop 1
    s_waitcnt lgkmcnt(4)
    v_mfma_f32_16x16x32_bf16 v[64:67], v[248:251], v[32:35], v[64:67]
    ds_read_b128 v[32:35], v6 offset:23040
    s_waitcnt lgkmcnt(3)
    v_mfma_f32_16x16x32_bf16 v[64:67], v[252:255], v[36:39], v[64:67]
    ds_read_b128 v[36:39], v7 offset:23040
    s_waitcnt lgkmcnt(3)
    v_mfma_f32_16x16x32_bf16 v[48:51], v[144:147], v[24:27], v[48:51]
    v_cvt_pk_bf16_f32 v44, v44, v45
    s_waitcnt lgkmcnt(2)
    v_mfma_f32_16x16x32_bf16 v[48:51], v[148:151], v[28:31], v[48:51]
    v_cvt_pk_bf16_f32 v45, v46, v47
    v_mfma_f32_16x16x32_bf16 v[68:71], v[224:227], v[24:27], v[68:71]
    v_cvt_pk_bf16_f32 v46, v64, v65
    v_mfma_f32_16x16x32_bf16 v[68:71], v[228:231], v[28:31], v[68:71]
    v_cvt_pk_bf16_f32 v47, v66, v67
    v_mfma_f32_16x16x32_bf16 v[52:55], v[128:131], v[24:27], v[52:55]
    v_mfma_f32_16x16x32_bf16 v[52:55], v[132:135], v[28:31], v[52:55]
    v_mfma_f32_16x16x32_bf16 v[56:59], v[112:115], v[24:27], v[56:59]
    v_mfma_f32_16x16x32_bf16 v[56:59], v[116:119], v[28:31], v[56:59]
    v_mfma_f32_16x16x32_bf16 v[60:63], v[96:99], v[24:27], v[60:63]
    v_mfma_f32_16x16x32_bf16 v[60:63], v[100:103], v[28:31], v[60:63]
    v_mfma_f32_16x16x32_bf16 v[40:43], v[80:83], v[24:27], 0
    v_mfma_f32_16x16x32_bf16 v[40:43], v[84:87], v[28:31], v[40:43]
    v_mfma_f32_16x16x32_bf16 v[72:75], v[192:195], v[24:27], v[72:75]
    v_mfma_f32_16x16x32_bf16 v[72:75], v[196:199], v[28:31], v[72:75]
    s_barrier
    v_mfma_f32_16x16x32_bf16 v[64:67], v[160:163], v[24:27], 0
    v_mfma_f32_16x16x32_bf16 v[64:67], v[164:167], v[28:31], v[64:67]
    ds_read_b128 v[24:27], v4 offset:26880
    s_waitcnt lgkmcnt(2)
    v_mfma_f32_16x16x32_bf16 v[48:51], v[152:155], v[32:35], v[48:51]
    ds_read_b128 v[28:31], v5 offset:26880
    s_waitcnt lgkmcnt(2)
    v_mfma_f32_16x16x32_bf16 v[48:51], v[156:159], v[36:39], v[48:51]
    v_mov_b32 v2, v76
    v_mfma_f32_16x16x32_bf16 v[68:71], v[232:235], v[32:35], v[68:71]
    v_mov_b32 v3, v77
    v_mfma_f32_16x16x32_bf16 v[68:71], v[236:239], v[36:39], v[68:71]
    v_mov_b32 v19, v78
    v_mfma_f32_16x16x32_bf16 v[52:55], v[136:139], v[32:35], v[52:55]
    v_mov_b32 v18, v79
    v_mfma_f32_16x16x32_bf16 v[52:55], v[140:143], v[36:39], v[52:55]
    v_cvt_pk_bf16_f32 v10, v48, v49
    v_mfma_f32_16x16x32_bf16 v[56:59], v[120:123], v[32:35], v[56:59]
    v_cvt_pk_bf16_f32 v11, v50, v51
    v_mfma_f32_16x16x32_bf16 v[56:59], v[124:127], v[36:39], v[56:59]
    v_mfma_f32_16x16x32_bf16 v[60:63], v[104:107], v[32:35], v[60:63]
    v_mfma_f32_16x16x32_bf16 v[60:63], v[108:111], v[36:39], v[60:63]
    v_mfma_f32_16x16x32_bf16 v[40:43], v[88:91], v[32:35], v[40:43]
    v_mfma_f32_16x16x32_bf16 v[40:43], v[92:95], v[36:39], v[40:43]
    v_mfma_f32_16x16x32_bf16 v[72:75], v[200:203], v[32:35], v[72:75]
    v_mfma_f32_16x16x32_bf16 v[72:75], v[204:207], v[36:39], v[72:75]
    v_mfma_f32_16x16x32_bf16 v[64:67], v[168:171], v[32:35], v[64:67]
    v_mfma_f32_16x16x32_bf16 v[64:67], v[172:175], v[36:39], v[64:67]
    ds_read_b128 v[32:35], v6 offset:26880
    s_waitcnt lgkmcnt(2)
    v_mfma_f32_16x16x32_bf16 v[52:55], v[144:147], v[24:27], v[52:55]
    ds_read_b128 v[36:39], v7 offset:26880
    s_waitcnt lgkmcnt(2)
    v_mfma_f32_16x16x32_bf16 v[52:55], v[148:151], v[28:31], v[52:55]
    v_mfma_f32_16x16x32_bf16 v[68:71], v[240:243], v[24:27], v[68:71]
    v_mfma_f32_16x16x32_bf16 v[68:71], v[244:247], v[28:31], v[68:71]
    v_mfma_f32_16x16x32_bf16 v[56:59], v[128:131], v[24:27], v[56:59]
    v_mfma_f32_16x16x32_bf16 v[56:59], v[132:135], v[28:31], v[56:59]
    v_mfma_f32_16x16x32_bf16 v[60:63], v[112:115], v[24:27], v[60:63]
    v_mfma_f32_16x16x32_bf16 v[60:63], v[116:119], v[28:31], v[60:63]
    v_mfma_f32_16x16x32_bf16 v[40:43], v[96:99], v[24:27], v[40:43]
    v_mfma_f32_16x16x32_bf16 v[40:43], v[100:103], v[28:31], v[40:43]
    v_mfma_f32_16x16x32_bf16 v[48:51], v[80:83], v[24:27], 0
    v_mfma_f32_16x16x32_bf16 v[48:51], v[84:87], v[28:31], v[48:51]
    v_mfma_f32_16x16x32_bf16 v[72:75], v[208:211], v[24:27], v[72:75]
    v_mfma_f32_16x16x32_bf16 v[72:75], v[212:215], v[28:31], v[72:75]
    s_barrier
    v_mfma_f32_16x16x32_bf16 v[64:67], v[176:179], v[24:27], v[64:67]
    v_mfma_f32_16x16x32_bf16 v[64:67], v[180:183], v[28:31], v[64:67]
    ds_read_b128 v[24:27], v4 offset:30720
    s_waitcnt lgkmcnt(2)
    v_mfma_f32_16x16x32_bf16 v[52:55], v[152:155], v[32:35], v[52:55]
    ds_read_b128 v[28:31], v5 offset:30720
    s_waitcnt lgkmcnt(2)
    v_mfma_f32_16x16x32_bf16 v[52:55], v[156:159], v[36:39], v[52:55]
    s_nop 1
    v_mfma_f32_16x16x32_bf16 v[68:71], v[248:251], v[32:35], v[68:71]
    s_nop 1
    v_mfma_f32_16x16x32_bf16 v[68:71], v[252:255], v[36:39], v[68:71]
    s_nop 0
    v_mfma_f32_16x16x32_bf16 v[56:59], v[136:139], v[32:35], v[56:59]
    v_cvt_pk_bf16_f32 v20, v52, v53
    v_mfma_f32_16x16x32_bf16 v[56:59], v[140:143], v[36:39], v[56:59]
    v_cvt_pk_bf16_f32 v21, v54, v55
    v_mfma_f32_16x16x32_bf16 v[60:63], v[120:123], v[32:35], v[60:63]
    s_nop 0
    v_mfma_f32_16x16x32_bf16 v[60:63], v[124:127], v[36:39], v[60:63]
    v_cvt_pk_bf16_f32 v14, v68, v69
    v_mfma_f32_16x16x32_bf16 v[40:43], v[104:107], v[32:35], v[40:43]
    v_cvt_pk_bf16_f32 v15, v70, v71
    v_mfma_f32_16x16x32_bf16 v[40:43], v[108:111], v[36:39], v[40:43]
    v_mfma_f32_16x16x32_bf16 v[48:51], v[88:91], v[32:35], v[48:51]
    v_mfma_f32_16x16x32_bf16 v[48:51], v[92:95], v[36:39], v[48:51]
    v_mfma_f32_16x16x32_bf16 v[72:75], v[216:219], v[32:35], v[72:75]
    v_mfma_f32_16x16x32_bf16 v[72:75], v[220:223], v[36:39], v[72:75]
    v_mfma_f32_16x16x32_bf16 v[64:67], v[184:187], v[32:35], v[64:67]
    v_mfma_f32_16x16x32_bf16 v[64:67], v[188:191], v[36:39], v[64:67]
    ds_read_b128 v[32:35], v6 offset:30720
    s_waitcnt lgkmcnt(2)
    v_mfma_f32_16x16x32_bf16 v[56:59], v[144:147], v[24:27], v[56:59]
    ds_read_b128 v[36:39], v7 offset:30720
    s_waitcnt lgkmcnt(2)
    v_mfma_f32_16x16x32_bf16 v[56:59], v[148:151], v[28:31], v[56:59]
    ds_read_b64_tr_b16 v[108:109], v18 offset:23168
    v_mfma_f32_16x16x32_bf16 v[72:75], v[224:227], v[24:27], v[72:75]
    ds_read_b64_tr_b16 v[110:111], v18 offset:23296
    v_mfma_f32_16x16x32_bf16 v[72:75], v[228:231], v[28:31], v[72:75]
    ds_read_b64_tr_b16 v[172:173], v18 offset:0
    v_mfma_f32_16x16x32_bf16 v[60:63], v[128:131], v[24:27], v[60:63]
    ds_read_b64_tr_b16 v[174:175], v18 offset:128
    v_mfma_f32_16x16x32_bf16 v[60:63], v[132:135], v[28:31], v[60:63]
    ds_read_b64_tr_b16 v[188:189], v0 offset:0
    v_mfma_f32_16x16x32_bf16 v[40:43], v[112:115], v[24:27], v[40:43]
    ds_read_b64_tr_b16 v[190:191], v0 offset:64
    v_mfma_f32_16x16x32_bf16 v[40:43], v[116:119], v[28:31], v[40:43]
    ds_read_b64_tr_b16 v[76:77], v18 offset:23552
    v_mfma_f32_16x16x32_bf16 v[48:51], v[96:99], v[24:27], v[48:51]
    ds_read_b64_tr_b16 v[78:79], v18 offset:23680
    v_mfma_f32_16x16x32_bf16 v[48:51], v[100:103], v[28:31], v[48:51]
    v_mfma_f32_16x16x32_bf16 v[52:55], v[80:83], v[24:27], 0
    v_mfma_f32_16x16x32_bf16 v[52:55], v[84:87], v[28:31], v[52:55]
    v_mfma_f32_16x16x32_bf16 v[64:67], v[192:195], v[24:27], v[64:67]
    v_mfma_f32_16x16x32_bf16 v[64:67], v[196:199], v[28:31], v[64:67]
    s_barrier
    v_mfma_f32_16x16x32_bf16 v[68:71], v[160:163], v[24:27], 0
    v_mfma_f32_16x16x32_bf16 v[68:71], v[164:167], v[28:31], v[68:71]
    ds_read_b128 v[24:27], v4 offset:34560
    s_waitcnt lgkmcnt(10)
    v_mfma_f32_16x16x32_bf16 v[56:59], v[152:155], v[32:35], v[56:59]
    ds_read_b128 v[28:31], v5 offset:34560
    s_waitcnt lgkmcnt(10)
    v_mfma_f32_16x16x32_bf16 v[56:59], v[156:159], v[36:39], v[56:59]
    s_nop 1
    v_mfma_f32_16x16x32_bf16 v[72:75], v[232:235], v[32:35], v[72:75]
    s_nop 1
    v_mfma_f32_16x16x32_bf16 v[72:75], v[236:239], v[36:39], v[72:75]
    s_nop 0
    v_mfma_f32_16x16x32_bf16 v[60:63], v[136:139], v[32:35], v[60:63]
    v_cvt_pk_bf16_f32 v16, v56, v57
    v_mfma_f32_16x16x32_bf16 v[60:63], v[140:143], v[36:39], v[60:63]
    v_cvt_pk_bf16_f32 v17, v58, v59
    v_mfma_f32_16x16x32_bf16 v[40:43], v[120:123], v[32:35], v[40:43]
    v_mfma_f32_16x16x32_bf16 v[40:43], v[124:127], v[36:39], v[40:43]
    v_mfma_f32_16x16x32_bf16 v[48:51], v[104:107], v[32:35], v[48:51]
    v_mfma_f32_16x16x32_bf16 v[52:55], v[88:91], v[32:35], v[52:55]
    v_mfma_f32_16x16x32_bf16 v[64:67], v[200:203], v[32:35], v[64:67]
    v_mfma_f32_16x16x32_bf16 v[64:67], v[204:207], v[36:39], v[64:67]
    v_mfma_f32_16x16x32_bf16 v[68:71], v[168:171], v[32:35], v[68:71]
    ds_read_b128 v[36:39], v7 offset:34560
    s_waitcnt lgkmcnt(2)
    v_mfma_f32_16x16x32_bf16 v[60:63], v[144:147], v[24:27], v[60:63]
    ds_read_b128 v[32:35], v6 offset:34560
    s_waitcnt lgkmcnt(2)
    v_mfma_f32_16x16x32_bf16 v[60:63], v[148:151], v[28:31], v[60:63]
    ds_write_b32 v12, v8 offset:0
    v_mfma_f32_16x16x32_bf16 v[72:75], v[240:243], v[24:27], v[72:75]
    ds_write_b32 v12, v9 offset:4
    v_mfma_f32_16x16x32_bf16 v[72:75], v[244:247], v[28:31], v[72:75]
    ds_write_b32 v12, v44 offset:3328
    v_mfma_f32_16x16x32_bf16 v[40:43], v[128:131], v[24:27], v[40:43]
    ds_write_b32 v12, v45 offset:3332
    v_mfma_f32_16x16x32_bf16 v[40:43], v[132:135], v[28:31], v[40:43]
    ds_write_b32 v13, v46 offset:0
    v_mfma_f32_16x16x32_bf16 v[48:51], v[112:115], v[24:27], v[48:51]
    ds_write_b32 v13, v47 offset:4
    v_mfma_f32_16x16x32_bf16 v[48:51], v[116:119], v[28:31], v[48:51]
    ds_write_b32 v12, v10 offset:6656
    v_mfma_f32_16x16x32_bf16 v[52:55], v[96:99], v[24:27], v[52:55]
    ds_write_b32 v12, v11 offset:6660
    v_mfma_f32_16x16x32_bf16 v[52:55], v[100:103], v[28:31], v[52:55]
    ds_write_b32 v12, v20 offset:9984
    v_mfma_f32_16x16x32_bf16 v[56:59], v[80:83], v[24:27], 0
    ds_write_b32 v12, v21 offset:9988
    v_mfma_f32_16x16x32_bf16 v[56:59], v[84:87], v[28:31], v[56:59]
    ds_write_b32 v13, v14 offset:6656
    v_mfma_f32_16x16x32_bf16 v[64:67], v[208:211], v[24:27], v[64:67]
    ds_write_b32 v13, v15 offset:6660
    v_mfma_f32_16x16x32_bf16 v[64:67], v[212:215], v[28:31], v[64:67]
    s_barrier
    v_mfma_f32_16x16x32_bf16 v[68:71], v[176:179], v[24:27], v[68:71]
    ds_write_b32 v12, v16 offset:23168
    v_mfma_f32_16x16x32_bf16 v[68:71], v[180:183], v[28:31], v[68:71]
    ds_read_b128 v[24:27], v4 offset:38400
    s_waitcnt lgkmcnt(14)
    v_mfma_f32_16x16x32_bf16 v[60:63], v[152:155], v[32:35], v[60:63]
    ds_read_b128 v[28:31], v5 offset:38400
    v_mfma_f32_16x16x32_bf16 v[60:63], v[156:159], v[36:39], v[60:63]
    ds_write_b32 v12, v17 offset:23172
    v_mfma_f32_16x16x32_bf16 v[72:75], v[248:251], v[32:35], v[72:75]
    s_nop 1
    v_mfma_f32_16x16x32_bf16 v[72:75], v[252:255], v[36:39], v[72:75]
    s_nop 1
    v_mfma_f32_16x16x32_bf16 v[40:43], v[136:139], v[32:35], v[40:43]
    v_cvt_pk_bf16_f32 v14, v60, v61
    v_mfma_f32_16x16x32_bf16 v[40:43], v[140:143], v[36:39], v[40:43]
    v_cvt_pk_bf16_f32 v15, v62, v63
    v_mfma_f32_16x16x32_bf16 v[48:51], v[120:123], v[32:35], v[48:51]
    ds_write_b32 v12, v14 offset:26496
    v_mfma_f32_16x16x32_bf16 v[52:55], v[104:107], v[32:35], v[52:55]
    ds_write_b32 v12, v15 offset:26500
    v_mfma_f32_16x16x32_bf16 v[56:59], v[88:91], v[32:35], v[56:59]
    v_cvt_pk_bf16_f32 v16, v72, v73
    v_mfma_f32_16x16x32_bf16 v[56:59], v[92:95], v[36:39], v[56:59]
    v_cvt_pk_bf16_f32 v17, v74, v75
    v_mfma_f32_16x16x32_bf16 v[64:67], v[216:219], v[32:35], v[64:67]
    ds_write_b32 v13, v16 offset:23168
    v_mfma_f32_16x16x32_bf16 v[64:67], v[220:223], v[36:39], v[64:67]
    ds_write_b32 v13, v17 offset:23172
    v_mfma_f32_16x16x32_bf16 v[68:71], v[184:187], v[32:35], v[68:71]
    ds_read_b128 v[36:39], v7 offset:38400
    s_waitcnt lgkmcnt(7)
    v_mfma_f32_16x16x32_bf16 v[40:43], v[144:147], v[24:27], v[40:43]
    ds_read_b128 v[32:35], v6 offset:38400
    s_waitcnt lgkmcnt(7)
    v_mfma_f32_16x16x32_bf16 v[40:43], v[148:151], v[28:31], v[40:43]
    v_mfma_f32_16x16x32_bf16 v[64:67], v[224:227], v[24:27], v[64:67]
    v_mfma_f32_16x16x32_bf16 v[64:67], v[228:231], v[28:31], v[64:67]
    v_mfma_f32_16x16x32_bf16 v[48:51], v[128:131], v[24:27], v[48:51]
    v_mfma_f32_16x16x32_bf16 v[48:51], v[132:135], v[28:31], v[48:51]
    s_waitcnt lgkmcnt(2)
    s_barrier
    v_mfma_f32_16x16x32_bf16 v[52:55], v[112:115], v[24:27], v[52:55]
    ds_read_b64_tr_b16 v[44:45], v18 offset:384
    v_mfma_f32_16x16x32_bf16 v[52:55], v[116:119], v[28:31], v[52:55]
    ds_read_b64_tr_b16 v[46:47], v18 offset:512
    v_mfma_f32_16x16x32_bf16 v[56:59], v[96:99], v[24:27], v[56:59]
    ds_read_b64_tr_b16 v[124:125], v0 offset:384
    v_mfma_f32_16x16x32_bf16 v[56:59], v[100:103], v[28:31], v[56:59]
    ds_read_b64_tr_b16 v[126:127], v0 offset:448
    v_mfma_f32_16x16x32_bf16 v[60:63], v[80:83], v[24:27], 0
    ds_read_b64_tr_b16 v[204:205], v18 offset:23936
    v_mfma_f32_16x16x32_bf16 v[60:63], v[84:87], v[28:31], v[60:63]
    ds_read_b64_tr_b16 v[206:207], v18 offset:24064
    v_mfma_f32_16x16x32_bf16 v[68:71], v[192:195], v[24:27], v[68:71]
    ds_read_b64_tr_b16 v[140:141], v18 offset:768
    v_mfma_f32_16x16x32_bf16 v[68:71], v[196:199], v[28:31], v[68:71]
    ds_read_b64_tr_b16 v[142:143], v18 offset:896
    v_mfma_f32_16x16x32_bf16 v[72:75], v[160:163], v[24:27], 0
    ds_read_b64_tr_b16 v[220:221], v0 offset:768
    v_mfma_f32_16x16x32_bf16 v[72:75], v[164:167], v[28:31], v[72:75]
    ds_read_b64_tr_b16 v[222:223], v0 offset:832
    s_waitcnt lgkmcnt(10)
    v_mfma_f32_16x16x32_bf16 v[40:43], v[152:155], v[32:35], v[40:43]
    ds_read_b128 v[24:27], v4 offset:42240
    v_mfma_f32_16x16x32_bf16 v[40:43], v[156:159], v[36:39], v[40:43]
    ds_read_b128 v[28:31], v5 offset:42240
    v_mfma_f32_16x16x32_bf16 v[64:67], v[232:235], v[32:35], v[64:67]
    ds_read_b128 v[8:11], v2 offset:30720
    v_mfma_f32_16x16x32_bf16 v[64:67], v[236:239], v[36:39], v[64:67]
    ds_read_b128 v[20:23], v3 offset:30720
    v_mfma_f32_16x16x32_bf16 v[48:51], v[136:139], v[32:35], v[48:51]
    ds_read_b128 v[36:39], v7 offset:42240
    v_mfma_f32_16x16x32_bf16 v[52:55], v[120:123], v[32:35], v[52:55]
    v_cvt_pk_bf16_f32 v14, v40, v41
    v_mfma_f32_16x16x32_bf16 v[56:59], v[104:107], v[32:35], v[56:59]
    v_cvt_pk_bf16_f32 v15, v42, v43
    v_mfma_f32_16x16x32_bf16 v[60:63], v[88:91], v[32:35], v[60:63]
    ds_write_b32 v12, v14 offset:29824
    v_mfma_f32_16x16x32_bf16 v[68:71], v[200:203], v[32:35], v[68:71]
    ds_write_b32 v12, v15 offset:29828
    v_mfma_f32_16x16x32_bf16 v[72:75], v[168:171], v[32:35], v[72:75]
    s_waitcnt lgkmcnt(4)
    v_mfma_f32_16x16x32_bf16 v[48:51], v[108:111], v[8:11], v[48:51]
    ds_read_b128 v[32:35], v6 offset:42240
    s_waitcnt lgkmcnt(4)
    v_mfma_f32_16x16x32_bf16 v[48:51], v[76:79], v[20:23], v[48:51]
    v_mfma_f32_16x16x32_bf16 v[52:55], v[172:175], v[8:11], v[52:55]
    v_mfma_f32_16x16x32_bf16 v[52:55], v[44:47], v[20:23], v[52:55]
    v_mfma_f32_16x16x32_bf16 v[68:71], v[188:191], v[8:11], v[68:71]
    ds_read_b128 v[8:11], v19 offset:30720
    v_mfma_f32_16x16x32_bf16 v[68:71], v[124:127], v[20:23], v[68:71]
    v_mfma_f32_16x16x32_bf16 v[48:51], v[144:147], v[24:27], v[48:51]
    v_mfma_f32_16x16x32_bf16 v[48:51], v[148:151], v[28:31], v[48:51]
    v_mfma_f32_16x16x32_bf16 v[64:67], v[240:243], v[24:27], v[64:67]
    v_mfma_f32_16x16x32_bf16 v[64:67], v[244:247], v[28:31], v[64:67]
    v_mfma_f32_16x16x32_bf16 v[52:55], v[128:131], v[24:27], v[52:55]
    v_mfma_f32_16x16x32_bf16 v[52:55], v[132:135], v[28:31], v[52:55]
    v_mfma_f32_16x16x32_bf16 v[56:59], v[112:115], v[24:27], v[56:59]
    v_mfma_f32_16x16x32_bf16 v[56:59], v[116:119], v[28:31], v[56:59]
    s_barrier
    v_mfma_f32_16x16x32_bf16 v[60:63], v[96:99], v[24:27], v[60:63]
    v_mfma_f32_16x16x32_bf16 v[60:63], v[100:103], v[28:31], v[60:63]
    v_mfma_f32_16x16x32_bf16 v[40:43], v[80:83], v[24:27], 0
    v_mfma_f32_16x16x32_bf16 v[40:43], v[84:87], v[28:31], v[40:43]
    v_mfma_f32_16x16x32_bf16 v[68:71], v[208:211], v[24:27], v[68:71]
    v_mfma_f32_16x16x32_bf16 v[68:71], v[212:215], v[28:31], v[68:71]
    v_mfma_f32_16x16x32_bf16 v[72:75], v[176:179], v[24:27], v[72:75]
    v_mfma_f32_16x16x32_bf16 v[72:75], v[180:183], v[28:31], v[72:75]
    ds_read_b128 v[24:27], v4 offset:46080
    s_waitcnt lgkmcnt(2)
    v_mfma_f32_16x16x32_bf16 v[48:51], v[152:155], v[32:35], v[48:51]
    ds_read_b128 v[28:31], v5 offset:46080
    s_waitcnt lgkmcnt(2)
    v_mfma_f32_16x16x32_bf16 v[48:51], v[204:207], v[8:11], v[48:51]
    s_nop 1
    v_mfma_f32_16x16x32_bf16 v[64:67], v[248:251], v[32:35], v[64:67]
    s_nop 1
    v_mfma_f32_16x16x32_bf16 v[64:67], v[252:255], v[36:39], v[64:67]
    s_nop 0
    v_mfma_f32_16x16x32_bf16 v[52:55], v[136:139], v[32:35], v[52:55]
    v_cvt_pk_bf16_f32 v16, v48, v49
    v_mfma_f32_16x16x32_bf16 v[52:55], v[140:143], v[8:11], v[52:55]
    v_cvt_pk_bf16_f32 v17, v50, v51
    v_mfma_f32_16x16x32_bf16 v[56:59], v[120:123], v[32:35], v[56:59]
    ds_write_b32 v12, v16 offset:33152
    v_mfma_f32_16x16x32_bf16 v[60:63], v[104:107], v[32:35], v[60:63]
    ds_write_b32 v12, v17 offset:33156
    v_mfma_f32_16x16x32_bf16 v[40:43], v[88:91], v[32:35], v[40:43]
    v_cvt_pk_bf16_f32 v14, v64, v65
    v_mfma_f32_16x16x32_bf16 v[40:43], v[92:95], v[36:39], v[40:43]
    v_cvt_pk_bf16_f32 v15, v66, v67
    v_mfma_f32_16x16x32_bf16 v[68:71], v[216:219], v[32:35], v[68:71]
    ds_read_b128 v[36:39], v7 offset:46080
    v_mfma_f32_16x16x32_bf16 v[68:71], v[220:223], v[8:11], v[68:71]
    ds_write_b32 v13, v14 offset:29824
    v_mfma_f32_16x16x32_bf16 v[72:75], v[184:187], v[32:35], v[72:75]
    ds_write_b32 v13, v15 offset:29828
    s_waitcnt lgkmcnt(6)
    v_mfma_f32_16x16x32_bf16 v[52:55], v[144:147], v[24:27], v[52:55]
    ds_read_b128 v[32:35], v6 offset:46080
    s_waitcnt lgkmcnt(6)
    v_mfma_f32_16x16x32_bf16 v[52:55], v[148:151], v[28:31], v[52:55]
    v_mfma_f32_16x16x32_bf16 v[68:71], v[224:227], v[24:27], v[68:71]
    v_mfma_f32_16x16x32_bf16 v[68:71], v[228:231], v[28:31], v[68:71]
    v_mfma_f32_16x16x32_bf16 v[56:59], v[128:131], v[24:27], v[56:59]
    s_waitcnt lgkmcnt(1)
    s_barrier
    v_mfma_f32_16x16x32_bf16 v[56:59], v[132:135], v[28:31], v[56:59]
    ds_read_b128 v[8:11], v2 offset:38400
    s_waitcnt lgkmcnt(1)
    v_mfma_f32_16x16x32_bf16 v[52:55], v[152:155], v[32:35], v[52:55]
    ds_read_b128 v[20:23], v3 offset:38400
    v_mfma_f32_16x16x32_bf16 v[52:55], v[156:159], v[36:39], v[52:55]
    ds_read_b128 v[80:83], v4 offset:49920
    v_mfma_f32_16x16x32_bf16 v[68:71], v[232:235], v[32:35], v[68:71]
    ds_read_b128 v[84:87], v5 offset:49920
    v_mfma_f32_16x16x32_bf16 v[68:71], v[236:239], v[36:39], v[68:71]
    ds_read_b128 v[88:91], v6 offset:49920
    v_mfma_f32_16x16x32_bf16 v[56:59], v[136:139], v[32:35], v[56:59]
    ds_read_b128 v[92:95], v7 offset:49920
    s_waitcnt lgkmcnt(5)
    v_mfma_f32_16x16x32_bf16 v[56:59], v[108:111], v[8:11], v[56:59]
    v_cvt_pk_bf16_f32 v16, v52, v53
    s_waitcnt lgkmcnt(4)
    v_mfma_f32_16x16x32_bf16 v[56:59], v[76:79], v[20:23], v[56:59]
    v_cvt_pk_bf16_f32 v17, v54, v55
    v_mfma_f32_16x16x32_bf16 v[60:63], v[172:175], v[8:11], v[60:63]
    ds_write_b32 v12, v16 offset:46336
    v_mfma_f32_16x16x32_bf16 v[60:63], v[44:47], v[20:23], v[60:63]
    ds_write_b32 v12, v17 offset:46340
    v_mfma_f32_16x16x32_bf16 v[72:75], v[188:191], v[8:11], v[72:75]
    ds_read_b128 v[8:11], v19 offset:38400
    v_mfma_f32_16x16x32_bf16 v[72:75], v[124:127], v[20:23], v[72:75]
    ds_read_b128 v[160:163], v4 offset:53760
    s_waitcnt lgkmcnt(7)
    v_mfma_f32_16x16x32_bf16 v[68:71], v[240:243], v[80:83], v[68:71]
    ds_read_b128 v[164:167], v5 offset:53760
    s_waitcnt lgkmcnt(7)
    v_mfma_f32_16x16x32_bf16 v[68:71], v[244:247], v[84:87], v[68:71]
    ds_read_b128 v[168:171], v6 offset:53760
    s_waitcnt lgkmcnt(7)
    v_mfma_f32_16x16x32_bf16 v[68:71], v[248:251], v[88:91], v[68:71]
    ds_read_b128 v[36:39], v7 offset:53760
    s_waitcnt lgkmcnt(7)
    v_mfma_f32_16x16x32_bf16 v[68:71], v[252:255], v[92:95], v[68:71]
    ds_read_b128 v[20:23], v3 offset:46080
    v_mfma_f32_16x16x32_bf16 v[56:59], v[144:147], v[80:83], v[56:59]
    ds_read_b128 v[176:179], v4 offset:57600
    v_mfma_f32_16x16x32_bf16 v[56:59], v[148:151], v[84:87], v[56:59]
    ds_read_b128 v[180:183], v5 offset:57600
    v_mfma_f32_16x16x32_bf16 v[56:59], v[152:155], v[88:91], v[56:59]
    ds_read_b128 v[184:187], v6 offset:57600
    s_waitcnt lgkmcnt(8)
    v_mfma_f32_16x16x32_bf16 v[56:59], v[204:207], v[8:11], v[56:59]
    ds_read_b128 v[92:95], v7 offset:57600
    v_mfma_f32_16x16x32_bf16 v[72:75], v[220:223], v[8:11], v[72:75]
    v_cvt_pk_bf16_f32 v14, v68, v69
    v_mfma_f32_16x16x32_bf16 v[72:75], v[192:195], v[24:27], v[72:75]
    v_cvt_pk_bf16_f32 v15, v70, v71
    v_mfma_f32_16x16x32_bf16 v[72:75], v[196:199], v[28:31], v[72:75]
    ds_write_b32 v13, v14 offset:46336
    v_mfma_f32_16x16x32_bf16 v[72:75], v[200:203], v[32:35], v[72:75]
    ds_write_b32 v13, v15 offset:46340
    v_mfma_f32_16x16x32_bf16 v[72:75], v[208:211], v[80:83], v[72:75]
    v_cvt_pk_bf16_f32 v16, v56, v57
    v_mfma_f32_16x16x32_bf16 v[72:75], v[212:215], v[84:87], v[72:75]
    v_cvt_pk_bf16_f32 v17, v58, v59
    v_mfma_f32_16x16x32_bf16 v[72:75], v[216:219], v[88:91], v[72:75]
    ds_write_b32 v12, v16 offset:49664
    v_mfma_f32_16x16x32_bf16 v[60:63], v[140:143], v[8:11], v[60:63]
    ds_write_b32 v12, v17 offset:49668
    v_mfma_f32_16x16x32_bf16 v[60:63], v[112:115], v[24:27], v[60:63]
    v_mfma_f32_16x16x32_bf16 v[60:63], v[116:119], v[28:31], v[60:63]
    v_mfma_f32_16x16x32_bf16 v[60:63], v[120:123], v[32:35], v[60:63]
    v_mfma_f32_16x16x32_bf16 v[60:63], v[128:131], v[80:83], v[60:63]
    v_mfma_f32_16x16x32_bf16 v[60:63], v[132:135], v[84:87], v[60:63]
    s_waitcnt lgkmcnt(0)
    s_barrier
    v_mfma_f32_16x16x32_bf16 v[60:63], v[136:139], v[88:91], v[60:63]
    ds_read_b128 v[8:11], v2 offset:46080
    v_mfma_f32_16x16x32_bf16 v[72:75], v[224:227], v[160:163], v[72:75]
    v_mfma_f32_16x16x32_bf16 v[72:75], v[228:231], v[164:167], v[72:75]
    v_mfma_f32_16x16x32_bf16 v[72:75], v[232:235], v[168:171], v[72:75]
    v_mfma_f32_16x16x32_bf16 v[72:75], v[236:239], v[36:39], v[72:75]
    v_mfma_f32_16x16x32_bf16 v[72:75], v[240:243], v[176:179], v[72:75]
    v_mfma_f32_16x16x32_bf16 v[72:75], v[244:247], v[180:183], v[72:75]
    v_mfma_f32_16x16x32_bf16 v[72:75], v[248:251], v[184:187], v[72:75]
    v_mfma_f32_16x16x32_bf16 v[72:75], v[252:255], v[92:95], v[72:75]
    s_nop 1
    v_mfma_f32_16x16x32_bf16 v[60:63], v[144:147], v[160:163], v[60:63]
    s_nop 1
    v_mfma_f32_16x16x32_bf16 v[60:63], v[148:151], v[164:167], v[60:63]
    s_nop 0
    v_mfma_f32_16x16x32_bf16 v[60:63], v[152:155], v[168:171], v[60:63]
    v_cvt_pk_bf16_f32 v14, v72, v73
    v_mfma_f32_16x16x32_bf16 v[60:63], v[156:159], v[36:39], v[60:63]
    v_cvt_pk_bf16_f32 v15, v74, v75
    s_waitcnt lgkmcnt(0)
    v_mfma_f32_16x16x32_bf16 v[40:43], v[108:111], v[8:11], v[40:43]
    ds_read_b128 v[8:11], v19 offset:46080
    v_mfma_f32_16x16x32_bf16 v[40:43], v[76:79], v[20:23], v[40:43]
    ds_write_b32 v13, v14 offset:52992
    v_mfma_f32_16x16x32_bf16 v[40:43], v[96:99], v[24:27], v[40:43]
    ds_write_b32 v13, v15 offset:52996
    v_mfma_f32_16x16x32_bf16 v[40:43], v[100:103], v[28:31], v[40:43]
    v_cvt_pk_bf16_f32 v16, v60, v61
    v_mfma_f32_16x16x32_bf16 v[40:43], v[104:107], v[32:35], v[40:43]
    v_cvt_pk_bf16_f32 v17, v62, v63
    v_mfma_f32_16x16x32_bf16 v[40:43], v[112:115], v[80:83], v[40:43]
    ds_write_b32 v12, v16 offset:52992
    v_mfma_f32_16x16x32_bf16 v[40:43], v[116:119], v[84:87], v[40:43]
    ds_write_b32 v12, v17 offset:52996
    v_mfma_f32_16x16x32_bf16 v[40:43], v[120:123], v[88:91], v[40:43]
    v_mfma_f32_16x16x32_bf16 v[40:43], v[128:131], v[160:163], v[40:43]
    v_mfma_f32_16x16x32_bf16 v[40:43], v[132:135], v[164:167], v[40:43]
    v_mfma_f32_16x16x32_bf16 v[40:43], v[136:139], v[168:171], v[40:43]
    v_mfma_f32_16x16x32_bf16 v[40:43], v[144:147], v[176:179], v[40:43]
    s_waitcnt lgkmcnt(0)
    s_barrier
    v_mfma_f32_16x16x32_bf16 v[40:43], v[148:151], v[180:183], v[40:43]
    v_mfma_f32_16x16x32_bf16 v[40:43], v[152:155], v[184:187], v[40:43]
    v_mfma_f32_16x16x32_bf16 v[40:43], v[204:207], v[8:11], v[40:43]
    s_nop 1
    s_nop 5
    v_cvt_pk_bf16_f32 v14, v40, v41
    v_cvt_pk_bf16_f32 v15, v42, v43
    ds_write_b64 v12, v[14:15] offset:56320
    s_waitcnt lgkmcnt(0)
    s_barrier
    s_endpgm
L_progend:
L_end:
    s_endpgm
.section .rodata,"a"
.p2align 6
.amdhsa_kernel standalone__grouped__vision_kernel
  .amdhsa_next_free_vgpr 256
  .amdhsa_next_free_sgpr 100
  .amdhsa_accum_offset 256
  .amdhsa_group_segment_fixed_size 0
  .amdhsa_kernarg_size 40
  .amdhsa_user_sgpr_count 2
  .amdhsa_user_sgpr_kernarg_segment_ptr 1
  .amdhsa_system_sgpr_workgroup_id_x 1
.end_amdhsa_kernel
```
